```python
import torch

def _softmax(x, axis=-1):
    return torch.softmax(x, dim=axis)
def _gelu(x):
    return torch.nn.functional.gelu(x, approximate="tanh")
def _silu(x):
    return torch.nn.functional.silu(x)
def _sigmoid(x):
    return torch.sigmoid(x)
def _layernorm(x, axis=-1, eps=1e-5):
    m = x.mean(dim=axis, keepdim=True)
    v = x.var(dim=axis, keepdim=True, unbiased=False)
    return (x - m) / torch.sqrt(v + eps)
def _scatter_add(tgt, idx, src, axis=0):
    return tgt.clone().index_add_(axis, idx, src)
def _segment_sum(src, seg, n):
    out = torch.zeros((n,) + src.shape[1:], dtype=src.dtype)
    return out.index_add_(0, seg, src)
def _pad(x, pw):
    flat = tuple(v for pair in reversed(pw) for v in pair)
    return torch.nn.functional.pad(x, flat)

kernel_name = 'parallel_sum__linear_kernel_hedgehog__swiglu_ffn__prompt'

def setup_inputs():

    _w = (lambda a: (lambda t: t.to(torch.bfloat16) if t.is_floating_point() else t)(torch.as_tensor(a)))
    def _A_setup():
        B, S, D, H = 1, 2048, 512, 32
        Dh = D // H
        return {
            "x": _w((lambda *s: torch.randn(*s, dtype=torch.bfloat16) * 0.05)(B, S, D)),
            "wqkv": _w((lambda *s: torch.randn(*s, dtype=torch.bfloat16) * 0.4)(D, 3 * D)),
            "w_phi": _w((lambda *s: torch.randn(*s, dtype=torch.bfloat16) * 0.4)(H, Dh, Dh) * (Dh ** -0.5)),
            "wo": _w((lambda *s: torch.randn(*s, dtype=torch.bfloat16) * 0.1)(D, D)),
        }
    _A_in = _A_setup()

    def _B_setup():
        B, S, D, F = 1, 2048, 512, 1792
        return {
            "x": _w((lambda *s: torch.randn(*s, dtype=torch.bfloat16) * 0.05)(B, S, D)),
            "w_gate": _w((lambda *s: torch.randn(*s, dtype=torch.bfloat16) * 0.05)(D, F)),
            "w_up": _w((lambda *s: torch.randn(*s, dtype=torch.bfloat16) * 0.05)(D, F)),
            "w_down": _w((lambda *s: torch.randn(*s, dtype=torch.bfloat16) * 0.05)(F, D)),
        }
    _B_in = _B_setup()

    return {
        "A_x": _A_in["x"],
        "A_wqkv": _A_in["wqkv"],
        "A_w_phi": _A_in["w_phi"],
        "A_wo": _A_in["wo"],
        "B_x": _B_in["x"],
        "B_w_gate": _B_in["w_gate"],
        "B_w_up": _B_in["w_up"],
        "B_w_down": _B_in["w_down"],
    }

def reference(A_x, A_wqkv, A_w_phi, A_wo, B_x, B_w_gate, B_w_up, B_w_down):
    def _A_ref(x, wqkv, w_phi, wo):
        B, S, D = x.shape
        H = 32; Dh = D // H
        qkv = (lambda x, *d: x.permute(*d))((x @ wqkv).reshape(B, S, 3, H, Dh), 2, 0, 3, 1, 4)
        q, k, v = qkv[0], qkv[1], qkv[2]
        pq = torch.einsum("bhsd,hdf->bhsf", q, w_phi)
        pk = torch.einsum("bhsd,hdf->bhsf", k, w_phi)
        phi_q = torch.concatenate([_softmax(pq, axis=-1), _softmax(-pq, axis=-1)], axis=-1)
        phi_k = torch.concatenate([_softmax(pk, axis=-1), _softmax(-pk, axis=-1)], axis=-1)
        kv = torch.einsum("bhsf,bhsd->bhfd", phi_k, v)
        z  = torch.einsum("bhsf->bhf", phi_k)
        num = torch.einsum("bhqf,bhfd->bhqd", phi_q, kv)
        den = torch.einsum("bhqf,bhf->bhq", phi_q, z)[..., None] + 1e-6
        o = num / den
        return (lambda x, *d: x.permute(*d))(o, 0, 2, 1, 3).reshape(B, S, D) @ wo

    def _B_ref(x, w_gate, w_up, w_down):
        g = _silu(x @ w_gate)
        u = x @ w_up
        return (g * u) @ w_down

    x = A_x
    xn = _layernorm(x, axis=-1)
    return x + _A_ref(xn, A_wqkv, A_w_phi, A_wo) + _B_ref(xn, B_w_gate, B_w_up, B_w_down)
```

```asm
; @launch grid=(256,1,1) block=(512,1,1) lds=163840
.amdgcn_target "amdgcn-amd-amdhsa--gfx950"
.text
.globl parallel_sum__linear_kernel_hedgehog__swiglu_ffn__prompt_kernel
.p2align 8
.type parallel_sum__linear_kernel_hedgehog__swiglu_ffn__prompt_kernel,@function
parallel_sum__linear_kernel_hedgehog__swiglu_ffn__prompt_kernel:
    s_cmp_ge_u32 s2, 256
    s_cbranch_scc1 L_end
    s_load_dwordx2 s[28:29], s[0:1], 0
    s_load_dwordx2 s[32:33], s[0:1], 8
    s_load_dwordx4 s[12:15], s[0:1], 40
    s_load_dwordx2 s[44:45], s[0:1], 16
    s_load_dwordx2 s[56:57], s[0:1], 24
    s_load_dwordx2 s[52:53], s[0:1], 56
    s_load_dwordx2 s[60:61], s[0:1], 64
    s_load_dwordx2 s[48:49], s[0:1], 72
    s_load_dwordx2 s[40:41], s[0:1], 80
    v_lshrrev_b32 v1, 6, v0
    v_and_b32 v0, 63, v0
    v_readfirstlane_b32 s64, v1
    s_cmp_lg_u32 s64, 7
    s_cbranch_scc1 L_nopfc
    s_getpc_b64 s[8:9]
L_pc:
    s_lshr_b32 s10, s2, 3
    s_and_b32 s10, s10, 7
    s_lshl_b32 s10, s10, 6
    v_add_u32 v2, s10, v0
    v_min_u32 v2, (L_last - L_pc) / 128, v2
    v_lshlrev_b32 v2, 7, v2
    global_load_dword v15, v2, s[8:9]
L_nopfc:

    s_mov_b32 s30, 0x200000
    s_mov_b32 s31, 0x00020000
    s_mov_b32 s34, 0x180000
    s_mov_b32 s35, 0x00020000
    s_mov_b32 s46, 0x4000
    s_mov_b32 s47, 0x00020000
    s_mov_b32 s58, 0x80000
    s_mov_b32 s59, 0x00020000
    s_mov_b32 s54, 0x1c0000
    s_mov_b32 s55, 0x00020000
    s_mov_b32 s62, 0x200000
    s_mov_b32 s63, 0x00020000
    s_mov_b32 s50, 0x100
    s_mov_b32 s51, 0x00020000
    s_mov_b32 s42, 0x2000000
    s_mov_b32 s43, 0x00020000
    s_mov_b32 s38, 0x1c0000
    s_mov_b32 s39, 0x00020000
    s_and_b32 s87, s2, 7
    s_lshr_b32 s88, s2, 3
    s_lshr_b32 s67, s87, 2
    s_lshl_b32 s67, s67, 3
    s_bfe_u32 s89, s88, 0x30001
    s_add_u32 s67, s67, s89
    s_lshr_b32 s78, s88, 4
    s_lshl_b32 s78, s78, 1
    s_and_b32 s89, s88, 1
    s_add_u32 s78, s78, s89
    s_mul_i32 s78, s78, 0
    s_lshr_b32 s89, s64, 2
    s_add_u32 s78, s78, s89
    s_and_b32 s78, s78, 3
    s_lshl_b32 s78, s78, 2
    s_and_b32 s89, s64, 3
    s_add_u32 s78, s78, s89
    s_lshl_b32 s90, s67, 4
    s_add_u32 s90, s90, s78
    s_lshl_b32 s90, s90, 13
    s_xor_b32 s91, s90, 0x10000
    v_lshrrev_b32 v32, 3, v0
    v_and_b32 v33, 7, v0
    v_lshlrev_b32 v1, 10, v32
    v_lshl_or_b32 v1, v33, 4, v1
    s_lshr_b32 s69, s88, 4
    s_and_b32 s68, s87, 3
    s_lshl_b32 s68, s68, 1
    s_and_b32 s89, s88, 1
    s_add_u32 s68, s68, s89
    s_lshl_b32 s26, s87, 2
    s_lshr_b32 s89, s88, 3
    s_add_u32 s26, s26, s89
    s_and_b32 s27, s88, 7
    s_and_b32 s65, s64, 3
    s_lshr_b32 s66, s64, 2
    s_lshl_b32 s70, s64, 11
    s_mov_b32 s79, 0x3fb8aa3b
    s_mov_b32 s80, 0xbfb8aa3b
    s_mov_b32 s81, 0xffff0000
    s_lshl_b32 s87, s78, 11
    s_and_b32 s88, s64, 1
    s_lshl_b32 s88, s88, 7
    s_add_u32 s87, s87, s88
    v_xor_b32 v36, v32, v33
    v_lshlrev_b32 v36, 4, v36
    v_lshl_add_u32 v36, v32, 8, v36
    v_add_u32 v36, s87, v36
    v_xor_b32 v37, 0x80, v36
    v_add_u32 v38, 0x10000, v36
    v_add_u32 v39, 0x10000, v37
    v_bfe_u32 v35, v0, 4, 1
    v_lshlrev_b32 v35, 2, v35
    v_xor_b32 v35, v35, v33
    v_mul_u32_u24 v10, 3072, v32
    v_lshl_add_u32 v10, v35, 4, v10
    s_lshl_b32 s87, s66, 1
    v_xor_b32 v35, s87, v35
    v_mul_u32_u24 v11, 3584, v32
    v_lshl_add_u32 v11, v35, 4, v11
    v_cmp_eq_u32_e64 vcc, s69, 0
    v_lshlrev_b32 v13, 4, v0
    s_nop 0
    v_cndmask_b32 v34, v11, v10, vcc
    s_waitcnt lgkmcnt(0)
    buffer_load_dwordx4 v[64:67], v1, s[28:31], s90 offen offset:0
    buffer_load_dwordx4 v[68:71], v1, s[28:31], s90 offen offset:128
    buffer_load_dwordx4 v[72:75], v1, s[28:31], s90 offen offset:256
    buffer_load_dwordx4 v[76:79], v1, s[28:31], s90 offen offset:384
    buffer_load_dwordx4 v[80:83], v1, s[28:31], s90 offen offset:512
    buffer_load_dwordx4 v[84:87], v1, s[28:31], s90 offen offset:640
    buffer_load_dwordx4 v[88:91], v1, s[28:31], s90 offen offset:768
    buffer_load_dwordx4 v[92:95], v1, s[28:31], s90 offen offset:896
    s_cmp_eq_u32 s66, 0
    s_cselect_b32 s36, s12, s14
    s_cselect_b32 s37, s13, s15
    s_mul_i32 s71, s64, 49152
    s_lshl_b32 s87, s68, 7
    s_add_u32 s71, s71, s87
    s_mul_i32 s73, s65, 57344
    s_add_u32 s88, s71, 1024
    s_lshl_b32 s87, s68, 8
    s_add_u32 s87, s87, s73
    s_mov_b32 s92, 393216
    s_mov_b32 s93, 24576
    s_cmp_eq_u32 s69, 0
    s_cselect_b32 s94, s88, s87
    s_cselect_b32 s92, s92, 229376
    s_cselect_b32 s93, s93, 28672
    s_cselect_b32 s4, s32, s36
    s_cselect_b32 s5, s33, s37
    s_cselect_b32 s6, s34, s38
    s_mov_b32 s7, 0x00020000
    v_and_b32 v22, 31, v0
    v_lshrrev_b32 v20, 5, v0
    v_and_b32 v23, 15, v0
    v_xor_b32 v23, v23, v20
    v_lshlrev_b32 v23, 4, v23
    s_lshl_b32 s87, s65, 13
    s_add_u32 s87, s87, 0x10000
    v_lshl_add_u32 v24, v22, 8, v23
    v_add_u32 v24, s87, v24
    v_bfe_u32 v17, v0, 2, 2
    v_and_b32 v18, 3, v0
    v_lshlrev_b32 v18, 3, v18
    v_bfe_u32 v19, v0, 4, 1
    v_bfe_u32 v21, v0, 3, 1
    v_lshlrev_b32 v21, 6, v21
    v_lshl_add_u32 v22, v20, 3, v17
    s_lshl_b32 s87, s66, 6
    v_lshl_or_b32 v23, v19, 5, s87
    v_xor_b32 v23, v23, v21
    v_add_u32 v23, v23, v18
    v_lshl_add_u32 v2, v22, 7, v23
    v_add_u32 v2, 0x10000, v2
    v_add_u32 v3, 0x10000, v2
    v_lshlrev_b32 v23, 13, v19
    v_add_u32 v4, v2, v23
    v_add_u32 v5, 0x10000, v4
    v_xor_b32 v6, 32, v4
    v_xor_b32 v7, 32, v5
    v_xor_b32 v25, 32, v24
    v_xor_b32 v26, 64, v24
    v_xor_b32 v27, 96, v24
    v_xor_b32 v28, 128, v24
    v_xor_b32 v29, 160, v24
    v_xor_b32 v30, 192, v24
    v_xor_b32 v31, 224, v24
    s_mov_b32 s95, 0x3f803f80
    s_setprio 1
    s_waitcnt vmcnt(7)
    v_lshlrev_b32 v128, 16, v64
    v_and_b32 v129, s81, v64
    v_pk_mul_f32 v[46:47], v[128:129], v[128:129]
    v_lshlrev_b32 v130, 16, v65
    v_and_b32 v131, s81, v65
    v_pk_add_f32 v[44:45], v[128:129], v[130:131]
    v_pk_fma_f32 v[46:47], v[130:131], v[130:131], v[46:47]
    buffer_load_dwordx4 v[96:99], v1, s[28:31], s91 offen offset:0
    v_lshlrev_b32 v132, 16, v66
    v_and_b32 v133, s81, v66
    v_pk_add_f32 v[44:45], v[44:45], v[132:133]
    v_pk_fma_f32 v[46:47], v[132:133], v[132:133], v[46:47]
    v_lshlrev_b32 v134, 16, v67
    v_and_b32 v135, s81, v67
    v_pk_add_f32 v[44:45], v[44:45], v[134:135]
    v_pk_fma_f32 v[46:47], v[134:135], v[134:135], v[46:47]
    s_waitcnt vmcnt(7)
    v_lshlrev_b32 v136, 16, v68
    v_and_b32 v137, s81, v68
    v_pk_add_f32 v[44:45], v[44:45], v[136:137]
    v_pk_fma_f32 v[46:47], v[136:137], v[136:137], v[46:47]
    v_lshlrev_b32 v138, 16, v69
    v_and_b32 v139, s81, v69
    v_pk_add_f32 v[44:45], v[44:45], v[138:139]
    v_pk_fma_f32 v[46:47], v[138:139], v[138:139], v[46:47]
    buffer_load_dwordx4 v[100:103], v1, s[28:31], s91 offen offset:128
    v_lshlrev_b32 v140, 16, v70
    v_and_b32 v141, s81, v70
    v_pk_add_f32 v[44:45], v[44:45], v[140:141]
    v_pk_fma_f32 v[46:47], v[140:141], v[140:141], v[46:47]
    v_lshlrev_b32 v142, 16, v71
    v_and_b32 v143, s81, v71
    v_pk_add_f32 v[44:45], v[44:45], v[142:143]
    v_pk_fma_f32 v[46:47], v[142:143], v[142:143], v[46:47]
    s_waitcnt vmcnt(7)
    v_lshlrev_b32 v144, 16, v72
    v_and_b32 v145, s81, v72
    v_pk_add_f32 v[44:45], v[44:45], v[144:145]
    v_pk_fma_f32 v[46:47], v[144:145], v[144:145], v[46:47]
    v_lshlrev_b32 v146, 16, v73
    v_and_b32 v147, s81, v73
    v_pk_add_f32 v[44:45], v[44:45], v[146:147]
    v_pk_fma_f32 v[46:47], v[146:147], v[146:147], v[46:47]
    buffer_load_dwordx4 v[104:107], v1, s[28:31], s91 offen offset:256
    v_lshlrev_b32 v148, 16, v74
    v_and_b32 v149, s81, v74
    v_pk_add_f32 v[44:45], v[44:45], v[148:149]
    v_pk_fma_f32 v[46:47], v[148:149], v[148:149], v[46:47]
    v_lshlrev_b32 v150, 16, v75
    v_and_b32 v151, s81, v75
    v_pk_add_f32 v[44:45], v[44:45], v[150:151]
    v_pk_fma_f32 v[46:47], v[150:151], v[150:151], v[46:47]
    s_waitcnt vmcnt(7)
    v_lshlrev_b32 v152, 16, v76
    v_and_b32 v153, s81, v76
    v_pk_add_f32 v[44:45], v[44:45], v[152:153]
    v_pk_fma_f32 v[46:47], v[152:153], v[152:153], v[46:47]
    v_lshlrev_b32 v154, 16, v77
    v_and_b32 v155, s81, v77
    v_pk_add_f32 v[44:45], v[44:45], v[154:155]
    v_pk_fma_f32 v[46:47], v[154:155], v[154:155], v[46:47]
    buffer_load_dwordx4 v[108:111], v1, s[28:31], s91 offen offset:384
    v_lshlrev_b32 v156, 16, v78
    v_and_b32 v157, s81, v78
    v_pk_add_f32 v[44:45], v[44:45], v[156:157]
    v_pk_fma_f32 v[46:47], v[156:157], v[156:157], v[46:47]
    v_lshlrev_b32 v158, 16, v79
    v_and_b32 v159, s81, v79
    v_pk_add_f32 v[44:45], v[44:45], v[158:159]
    v_pk_fma_f32 v[46:47], v[158:159], v[158:159], v[46:47]
    s_waitcnt vmcnt(7)
    v_lshlrev_b32 v160, 16, v80
    v_and_b32 v161, s81, v80
    v_pk_add_f32 v[44:45], v[44:45], v[160:161]
    v_pk_fma_f32 v[46:47], v[160:161], v[160:161], v[46:47]
    v_lshlrev_b32 v162, 16, v81
    v_and_b32 v163, s81, v81
    v_pk_add_f32 v[44:45], v[44:45], v[162:163]
    v_pk_fma_f32 v[46:47], v[162:163], v[162:163], v[46:47]
    buffer_load_dwordx4 v[112:115], v1, s[28:31], s91 offen offset:512
    v_lshlrev_b32 v164, 16, v82
    v_and_b32 v165, s81, v82
    v_pk_add_f32 v[44:45], v[44:45], v[164:165]
    v_pk_fma_f32 v[46:47], v[164:165], v[164:165], v[46:47]
    v_lshlrev_b32 v166, 16, v83
    v_and_b32 v167, s81, v83
    v_pk_add_f32 v[44:45], v[44:45], v[166:167]
    v_pk_fma_f32 v[46:47], v[166:167], v[166:167], v[46:47]
    s_waitcnt vmcnt(7)
    v_lshlrev_b32 v168, 16, v84
    v_and_b32 v169, s81, v84
    v_pk_add_f32 v[44:45], v[44:45], v[168:169]
    v_pk_fma_f32 v[46:47], v[168:169], v[168:169], v[46:47]
    v_lshlrev_b32 v170, 16, v85
    v_and_b32 v171, s81, v85
    v_pk_add_f32 v[44:45], v[44:45], v[170:171]
    v_pk_fma_f32 v[46:47], v[170:171], v[170:171], v[46:47]
    buffer_load_dwordx4 v[116:119], v1, s[28:31], s91 offen offset:640
    v_lshlrev_b32 v172, 16, v86
    v_and_b32 v173, s81, v86
    v_pk_add_f32 v[44:45], v[44:45], v[172:173]
    v_pk_fma_f32 v[46:47], v[172:173], v[172:173], v[46:47]
    v_lshlrev_b32 v174, 16, v87
    v_and_b32 v175, s81, v87
    v_pk_add_f32 v[44:45], v[44:45], v[174:175]
    v_pk_fma_f32 v[46:47], v[174:175], v[174:175], v[46:47]
    s_waitcnt vmcnt(7)
    v_lshlrev_b32 v176, 16, v88
    v_and_b32 v177, s81, v88
    v_pk_add_f32 v[44:45], v[44:45], v[176:177]
    v_pk_fma_f32 v[46:47], v[176:177], v[176:177], v[46:47]
    v_lshlrev_b32 v178, 16, v89
    v_and_b32 v179, s81, v89
    v_pk_add_f32 v[44:45], v[44:45], v[178:179]
    v_pk_fma_f32 v[46:47], v[178:179], v[178:179], v[46:47]
    buffer_load_dwordx4 v[120:123], v1, s[28:31], s91 offen offset:768
    v_lshlrev_b32 v180, 16, v90
    v_and_b32 v181, s81, v90
    v_pk_add_f32 v[44:45], v[44:45], v[180:181]
    v_pk_fma_f32 v[46:47], v[180:181], v[180:181], v[46:47]
    v_lshlrev_b32 v182, 16, v91
    v_and_b32 v183, s81, v91
    v_pk_add_f32 v[44:45], v[44:45], v[182:183]
    v_pk_fma_f32 v[46:47], v[182:183], v[182:183], v[46:47]
    s_waitcnt vmcnt(7)
    v_lshlrev_b32 v184, 16, v92
    v_and_b32 v185, s81, v92
    v_pk_add_f32 v[44:45], v[44:45], v[184:185]
    v_pk_fma_f32 v[46:47], v[184:185], v[184:185], v[46:47]
    v_lshlrev_b32 v186, 16, v93
    v_and_b32 v187, s81, v93
    v_pk_add_f32 v[44:45], v[44:45], v[186:187]
    v_pk_fma_f32 v[46:47], v[186:187], v[186:187], v[46:47]
    buffer_load_dwordx4 v[124:127], v1, s[28:31], s91 offen offset:896
    v_lshlrev_b32 v188, 16, v94
    v_and_b32 v189, s81, v94
    v_pk_add_f32 v[44:45], v[44:45], v[188:189]
    v_pk_fma_f32 v[46:47], v[188:189], v[188:189], v[46:47]
    v_lshlrev_b32 v190, 16, v95
    v_and_b32 v191, s81, v95
    v_pk_add_f32 v[44:45], v[44:45], v[190:191]
    v_pk_fma_f32 v[46:47], v[190:191], v[190:191], v[46:47]
    s_cmp_lg_u32 s66, 0
    s_cbranch_scc1 L_keepprio
    s_setprio 0
L_keepprio:
    v_add_f32 v44, v44, v45
    v_add_f32 v46, v46, v47
    s_nop 0
    v_add_f32_dpp v44, v44, v44 quad_perm:[1,0,3,2] row_mask:0xf bank_mask:0xf
    v_add_f32_dpp v46, v46, v46 quad_perm:[1,0,3,2] row_mask:0xf bank_mask:0xf
    s_nop 0
    v_add_f32_dpp v44, v44, v44 quad_perm:[2,3,0,1] row_mask:0xf bank_mask:0xf
    v_add_f32_dpp v46, v46, v46 quad_perm:[2,3,0,1] row_mask:0xf bank_mask:0xf
    s_nop 0
    v_add_f32_dpp v44, v44, v44 row_half_mirror row_mask:0xf bank_mask:0xf
    v_add_f32_dpp v46, v46, v46 row_half_mirror row_mask:0xf bank_mask:0xf
    v_mul_f32 v44, 0x3b000000, v44
    v_mul_f32 v46, 0x3b000000, v46
    v_fma_f32 v46, -v44, v44, v46
    v_max_f32 v46, 0, v46
    v_add_f32 v46, 0x3727c5ac, v46
    v_rsq_f32 v46, v46
    s_nop 0
    v_mul_f32_e64 v44, -v44, v46
    s_add_u32 m0, s70, 131072
    s_nop 0
    buffer_load_dwordx4 v34, s[4:7], s94 offen lds
    s_add_u32 m0, s70, 132096
    s_add_u32 s94, s94, s93
    buffer_load_dwordx4 v34, s[4:7], s94 offen lds
    s_add_u32 m0, s70, 147456
    s_add_u32 s94, s94, s92
    s_sub_u32 s94, s94, s93
    buffer_load_dwordx4 v34, s[4:7], s94 offen lds
    s_add_u32 m0, s70, 148480
    s_add_u32 s94, s94, s93
    buffer_load_dwordx4 v34, s[4:7], s94 offen lds
    s_cmp_lt_u32 s64, 4
    s_cbranch_scc1 L_pfa_end
    v_min_u32 v42, 55, v0
    v_lshlrev_b32 v42, 7, v42
    s_mul_i32 s87, s2, 7168
    s_cmp_eq_u32 s64, 5
    s_cbranch_scc1 L_pfa_5
    s_cmp_eq_u32 s64, 6
    s_cbranch_scc1 L_pfa_6
    s_cmp_eq_u32 s64, 7
    s_cbranch_scc1 L_pfa_7
    v_min_u32 v42, 6016, v42
    s_mul_i32 s87, s2, 6144
    buffer_load_dword v40, v42, s[32:35], s87 offen
    s_branch L_pfa_end
L_pfa_5:
    buffer_load_dword v40, v42, s[36:39], s87 offen
    s_branch L_pfa_end
L_pfa_6:
    v_add_u32 v42, s87, v42
    global_load_dword v40, v42, s[12:13]
    s_branch L_pfa_end
L_pfa_7:
    buffer_load_dword v40, v42, s[52:55], s87 offen
    v_min_u32 v42, 1920, v42
    s_lshl_b32 s87, s2, 11
    buffer_load_dword v41, v42, s[56:59], s87 offen
L_pfa_end:

    v_pk_fma_f32 v[128:129], v[128:129], v[46:47], v[44:45] op_sel_hi:[1,0,0]
    v_pk_fma_f32 v[130:131], v[130:131], v[46:47], v[44:45] op_sel_hi:[1,0,0]
    v_pk_fma_f32 v[132:133], v[132:133], v[46:47], v[44:45] op_sel_hi:[1,0,0]
    v_pk_fma_f32 v[134:135], v[134:135], v[46:47], v[44:45] op_sel_hi:[1,0,0]
    v_cvt_pk_bf16_f32 v64, v128, v129
    v_cvt_pk_bf16_f32 v65, v130, v131
    v_cvt_pk_bf16_f32 v66, v132, v133
    v_cvt_pk_bf16_f32 v67, v134, v135
    ds_write_b128 v38, v[64:67] offset:0
    v_pk_fma_f32 v[136:137], v[136:137], v[46:47], v[44:45] op_sel_hi:[1,0,0]
    v_pk_fma_f32 v[138:139], v[138:139], v[46:47], v[44:45] op_sel_hi:[1,0,0]
    v_pk_fma_f32 v[140:141], v[140:141], v[46:47], v[44:45] op_sel_hi:[1,0,0]
    v_pk_fma_f32 v[142:143], v[142:143], v[46:47], v[44:45] op_sel_hi:[1,0,0]
    v_cvt_pk_bf16_f32 v68, v136, v137
    v_cvt_pk_bf16_f32 v69, v138, v139
    v_cvt_pk_bf16_f32 v70, v140, v141
    v_cvt_pk_bf16_f32 v71, v142, v143
    ds_write_b128 v39, v[68:71] offset:0
    v_pk_fma_f32 v[144:145], v[144:145], v[46:47], v[44:45] op_sel_hi:[1,0,0]
    v_pk_fma_f32 v[146:147], v[146:147], v[46:47], v[44:45] op_sel_hi:[1,0,0]
    v_pk_fma_f32 v[148:149], v[148:149], v[46:47], v[44:45] op_sel_hi:[1,0,0]
    v_pk_fma_f32 v[150:151], v[150:151], v[46:47], v[44:45] op_sel_hi:[1,0,0]
    v_cvt_pk_bf16_f32 v72, v144, v145
    v_cvt_pk_bf16_f32 v73, v146, v147
    v_cvt_pk_bf16_f32 v74, v148, v149
    v_cvt_pk_bf16_f32 v75, v150, v151
    ds_write_b128 v38, v[72:75] offset:32768
    v_pk_fma_f32 v[152:153], v[152:153], v[46:47], v[44:45] op_sel_hi:[1,0,0]
    v_pk_fma_f32 v[154:155], v[154:155], v[46:47], v[44:45] op_sel_hi:[1,0,0]
    v_pk_fma_f32 v[156:157], v[156:157], v[46:47], v[44:45] op_sel_hi:[1,0,0]
    v_pk_fma_f32 v[158:159], v[158:159], v[46:47], v[44:45] op_sel_hi:[1,0,0]
    v_cvt_pk_bf16_f32 v76, v152, v153
    v_cvt_pk_bf16_f32 v77, v154, v155
    v_cvt_pk_bf16_f32 v78, v156, v157
    v_cvt_pk_bf16_f32 v79, v158, v159
    ds_write_b128 v39, v[76:79] offset:32768
    v_pk_fma_f32 v[160:161], v[160:161], v[46:47], v[44:45] op_sel_hi:[1,0,0]
    v_pk_fma_f32 v[162:163], v[162:163], v[46:47], v[44:45] op_sel_hi:[1,0,0]
    v_pk_fma_f32 v[164:165], v[164:165], v[46:47], v[44:45] op_sel_hi:[1,0,0]
    v_pk_fma_f32 v[166:167], v[166:167], v[46:47], v[44:45] op_sel_hi:[1,0,0]
    v_cvt_pk_bf16_f32 v80, v160, v161
    v_cvt_pk_bf16_f32 v81, v162, v163
    v_cvt_pk_bf16_f32 v82, v164, v165
    v_cvt_pk_bf16_f32 v83, v166, v167
    ds_write_b128 v36, v[80:83] offset:0
    v_pk_fma_f32 v[168:169], v[168:169], v[46:47], v[44:45] op_sel_hi:[1,0,0]
    v_pk_fma_f32 v[170:171], v[170:171], v[46:47], v[44:45] op_sel_hi:[1,0,0]
    v_pk_fma_f32 v[172:173], v[172:173], v[46:47], v[44:45] op_sel_hi:[1,0,0]
    v_pk_fma_f32 v[174:175], v[174:175], v[46:47], v[44:45] op_sel_hi:[1,0,0]
    v_cvt_pk_bf16_f32 v84, v168, v169
    v_cvt_pk_bf16_f32 v85, v170, v171
    v_cvt_pk_bf16_f32 v86, v172, v173
    v_cvt_pk_bf16_f32 v87, v174, v175
    ds_write_b128 v37, v[84:87] offset:0
    v_pk_fma_f32 v[176:177], v[176:177], v[46:47], v[44:45] op_sel_hi:[1,0,0]
    v_pk_fma_f32 v[178:179], v[178:179], v[46:47], v[44:45] op_sel_hi:[1,0,0]
    v_pk_fma_f32 v[180:181], v[180:181], v[46:47], v[44:45] op_sel_hi:[1,0,0]
    v_pk_fma_f32 v[182:183], v[182:183], v[46:47], v[44:45] op_sel_hi:[1,0,0]
    v_cvt_pk_bf16_f32 v88, v176, v177
    v_cvt_pk_bf16_f32 v89, v178, v179
    v_cvt_pk_bf16_f32 v90, v180, v181
    v_cvt_pk_bf16_f32 v91, v182, v183
    ds_write_b128 v36, v[88:91] offset:32768
    v_pk_fma_f32 v[184:185], v[184:185], v[46:47], v[44:45] op_sel_hi:[1,0,0]
    v_pk_fma_f32 v[186:187], v[186:187], v[46:47], v[44:45] op_sel_hi:[1,0,0]
    v_pk_fma_f32 v[188:189], v[188:189], v[46:47], v[44:45] op_sel_hi:[1,0,0]
    v_pk_fma_f32 v[190:191], v[190:191], v[46:47], v[44:45] op_sel_hi:[1,0,0]
    v_cvt_pk_bf16_f32 v92, v184, v185
    v_cvt_pk_bf16_f32 v93, v186, v187
    v_cvt_pk_bf16_f32 v94, v188, v189
    v_cvt_pk_bf16_f32 v95, v190, v191
    ds_write_b128 v37, v[92:95] offset:32768
    v_xor_b32 v36, 0x4000, v36
    v_xor_b32 v37, 0x4000, v37
    v_xor_b32 v38, 0x4000, v38
    v_xor_b32 v39, 0x4000, v39
    s_waitcnt vmcnt(11)
    v_lshlrev_b32 v192, 16, v96
    v_and_b32 v193, s81, v96
    v_pk_mul_f32 v[46:47], v[192:193], v[192:193]
    v_lshlrev_b32 v194, 16, v97
    v_and_b32 v195, s81, v97
    v_pk_add_f32 v[44:45], v[192:193], v[194:195]
    v_pk_fma_f32 v[46:47], v[194:195], v[194:195], v[46:47]
    v_lshlrev_b32 v196, 16, v98
    v_and_b32 v197, s81, v98
    v_pk_add_f32 v[44:45], v[44:45], v[196:197]
    v_pk_fma_f32 v[46:47], v[196:197], v[196:197], v[46:47]
    v_lshlrev_b32 v198, 16, v99
    v_and_b32 v199, s81, v99
    v_pk_add_f32 v[44:45], v[44:45], v[198:199]
    v_pk_fma_f32 v[46:47], v[198:199], v[198:199], v[46:47]
    s_waitcnt vmcnt(10)
    v_lshlrev_b32 v200, 16, v100
    v_and_b32 v201, s81, v100
    v_pk_add_f32 v[44:45], v[44:45], v[200:201]
    v_pk_fma_f32 v[46:47], v[200:201], v[200:201], v[46:47]
    v_lshlrev_b32 v202, 16, v101
    v_and_b32 v203, s81, v101
    v_pk_add_f32 v[44:45], v[44:45], v[202:203]
    v_pk_fma_f32 v[46:47], v[202:203], v[202:203], v[46:47]
    v_lshlrev_b32 v204, 16, v102
    v_and_b32 v205, s81, v102
    v_pk_add_f32 v[44:45], v[44:45], v[204:205]
    v_pk_fma_f32 v[46:47], v[204:205], v[204:205], v[46:47]
    v_lshlrev_b32 v206, 16, v103
    v_and_b32 v207, s81, v103
    v_pk_add_f32 v[44:45], v[44:45], v[206:207]
    v_pk_fma_f32 v[46:47], v[206:207], v[206:207], v[46:47]
    s_waitcnt vmcnt(9)
    v_lshlrev_b32 v208, 16, v104
    v_and_b32 v209, s81, v104
    v_pk_add_f32 v[44:45], v[44:45], v[208:209]
    v_pk_fma_f32 v[46:47], v[208:209], v[208:209], v[46:47]
    v_lshlrev_b32 v210, 16, v105
    v_and_b32 v211, s81, v105
    v_pk_add_f32 v[44:45], v[44:45], v[210:211]
    v_pk_fma_f32 v[46:47], v[210:211], v[210:211], v[46:47]
    v_lshlrev_b32 v212, 16, v106
    v_and_b32 v213, s81, v106
    v_pk_add_f32 v[44:45], v[44:45], v[212:213]
    v_pk_fma_f32 v[46:47], v[212:213], v[212:213], v[46:47]
    v_lshlrev_b32 v214, 16, v107
    v_and_b32 v215, s81, v107
    v_pk_add_f32 v[44:45], v[44:45], v[214:215]
    v_pk_fma_f32 v[46:47], v[214:215], v[214:215], v[46:47]
    s_waitcnt vmcnt(8)
    v_lshlrev_b32 v216, 16, v108
    v_and_b32 v217, s81, v108
    v_pk_add_f32 v[44:45], v[44:45], v[216:217]
    v_pk_fma_f32 v[46:47], v[216:217], v[216:217], v[46:47]
    v_lshlrev_b32 v218, 16, v109
    v_and_b32 v219, s81, v109
    v_pk_add_f32 v[44:45], v[44:45], v[218:219]
    v_pk_fma_f32 v[46:47], v[218:219], v[218:219], v[46:47]
    v_lshlrev_b32 v220, 16, v110
    v_and_b32 v221, s81, v110
    v_pk_add_f32 v[44:45], v[44:45], v[220:221]
    v_pk_fma_f32 v[46:47], v[220:221], v[220:221], v[46:47]
    v_lshlrev_b32 v222, 16, v111
    v_and_b32 v223, s81, v111
    v_pk_add_f32 v[44:45], v[44:45], v[222:223]
    v_pk_fma_f32 v[46:47], v[222:223], v[222:223], v[46:47]
    s_waitcnt vmcnt(7)
    v_lshlrev_b32 v224, 16, v112
    v_and_b32 v225, s81, v112
    v_pk_add_f32 v[44:45], v[44:45], v[224:225]
    v_pk_fma_f32 v[46:47], v[224:225], v[224:225], v[46:47]
    v_lshlrev_b32 v226, 16, v113
    v_and_b32 v227, s81, v113
    v_pk_add_f32 v[44:45], v[44:45], v[226:227]
    v_pk_fma_f32 v[46:47], v[226:227], v[226:227], v[46:47]
    v_lshlrev_b32 v228, 16, v114
    v_and_b32 v229, s81, v114
    v_pk_add_f32 v[44:45], v[44:45], v[228:229]
    v_pk_fma_f32 v[46:47], v[228:229], v[228:229], v[46:47]
    v_lshlrev_b32 v230, 16, v115
    v_and_b32 v231, s81, v115
    v_pk_add_f32 v[44:45], v[44:45], v[230:231]
    v_pk_fma_f32 v[46:47], v[230:231], v[230:231], v[46:47]
    s_waitcnt vmcnt(6)
    v_lshlrev_b32 v232, 16, v116
    v_and_b32 v233, s81, v116
    v_pk_add_f32 v[44:45], v[44:45], v[232:233]
    v_pk_fma_f32 v[46:47], v[232:233], v[232:233], v[46:47]
    v_lshlrev_b32 v234, 16, v117
    v_and_b32 v235, s81, v117
    v_pk_add_f32 v[44:45], v[44:45], v[234:235]
    v_pk_fma_f32 v[46:47], v[234:235], v[234:235], v[46:47]
    v_lshlrev_b32 v236, 16, v118
    v_and_b32 v237, s81, v118
    v_pk_add_f32 v[44:45], v[44:45], v[236:237]
    v_pk_fma_f32 v[46:47], v[236:237], v[236:237], v[46:47]
    v_lshlrev_b32 v238, 16, v119
    v_and_b32 v239, s81, v119
    v_pk_add_f32 v[44:45], v[44:45], v[238:239]
    v_pk_fma_f32 v[46:47], v[238:239], v[238:239], v[46:47]
    s_waitcnt vmcnt(5)
    v_lshlrev_b32 v240, 16, v120
    v_and_b32 v241, s81, v120
    v_pk_add_f32 v[44:45], v[44:45], v[240:241]
    v_pk_fma_f32 v[46:47], v[240:241], v[240:241], v[46:47]
    v_lshlrev_b32 v242, 16, v121
    v_and_b32 v243, s81, v121
    v_pk_add_f32 v[44:45], v[44:45], v[242:243]
    v_pk_fma_f32 v[46:47], v[242:243], v[242:243], v[46:47]
    v_lshlrev_b32 v244, 16, v122
    v_and_b32 v245, s81, v122
    v_pk_add_f32 v[44:45], v[44:45], v[244:245]
    v_pk_fma_f32 v[46:47], v[244:245], v[244:245], v[46:47]
    v_lshlrev_b32 v246, 16, v123
    v_and_b32 v247, s81, v123
    v_pk_add_f32 v[44:45], v[44:45], v[246:247]
    v_pk_fma_f32 v[46:47], v[246:247], v[246:247], v[46:47]
    s_waitcnt vmcnt(4)
    v_lshlrev_b32 v248, 16, v124
    v_and_b32 v249, s81, v124
    v_pk_add_f32 v[44:45], v[44:45], v[248:249]
    v_pk_fma_f32 v[46:47], v[248:249], v[248:249], v[46:47]
    v_lshlrev_b32 v250, 16, v125
    v_and_b32 v251, s81, v125
    v_pk_add_f32 v[44:45], v[44:45], v[250:251]
    v_pk_fma_f32 v[46:47], v[250:251], v[250:251], v[46:47]
    v_lshlrev_b32 v252, 16, v126
    v_and_b32 v253, s81, v126
    v_pk_add_f32 v[44:45], v[44:45], v[252:253]
    v_pk_fma_f32 v[46:47], v[252:253], v[252:253], v[46:47]
    v_lshlrev_b32 v254, 16, v127
    v_and_b32 v255, s81, v127
    v_pk_add_f32 v[44:45], v[44:45], v[254:255]
    v_pk_fma_f32 v[46:47], v[254:255], v[254:255], v[46:47]
    s_setprio 0
    v_add_f32 v44, v44, v45
    v_add_f32 v46, v46, v47
    s_nop 0
    v_add_f32_dpp v44, v44, v44 quad_perm:[1,0,3,2] row_mask:0xf bank_mask:0xf
    v_add_f32_dpp v46, v46, v46 quad_perm:[1,0,3,2] row_mask:0xf bank_mask:0xf
    s_nop 0
    v_add_f32_dpp v44, v44, v44 quad_perm:[2,3,0,1] row_mask:0xf bank_mask:0xf
    v_add_f32_dpp v46, v46, v46 quad_perm:[2,3,0,1] row_mask:0xf bank_mask:0xf
    s_nop 0
    v_add_f32_dpp v44, v44, v44 row_half_mirror row_mask:0xf bank_mask:0xf
    v_add_f32_dpp v46, v46, v46 row_half_mirror row_mask:0xf bank_mask:0xf
    v_mul_f32 v44, 0x3b000000, v44
    v_mul_f32 v46, 0x3b000000, v46
    v_fma_f32 v46, -v44, v44, v46
    v_max_f32 v46, 0, v46
    v_add_f32 v46, 0x3727c5ac, v46
    v_rsq_f32 v46, v46
    s_nop 0
    v_mul_f32_e64 v44, -v44, v46
    v_pk_fma_f32 v[192:193], v[192:193], v[46:47], v[44:45] op_sel_hi:[1,0,0]
    v_pk_fma_f32 v[194:195], v[194:195], v[46:47], v[44:45] op_sel_hi:[1,0,0]
    v_pk_fma_f32 v[196:197], v[196:197], v[46:47], v[44:45] op_sel_hi:[1,0,0]
    v_pk_fma_f32 v[198:199], v[198:199], v[46:47], v[44:45] op_sel_hi:[1,0,0]
    v_cvt_pk_bf16_f32 v96, v192, v193
    v_cvt_pk_bf16_f32 v97, v194, v195
    v_cvt_pk_bf16_f32 v98, v196, v197
    v_cvt_pk_bf16_f32 v99, v198, v199
    ds_write_b128 v38, v[96:99] offset:0
    v_pk_fma_f32 v[200:201], v[200:201], v[46:47], v[44:45] op_sel_hi:[1,0,0]
    v_pk_fma_f32 v[202:203], v[202:203], v[46:47], v[44:45] op_sel_hi:[1,0,0]
    v_pk_fma_f32 v[204:205], v[204:205], v[46:47], v[44:45] op_sel_hi:[1,0,0]
    v_pk_fma_f32 v[206:207], v[206:207], v[46:47], v[44:45] op_sel_hi:[1,0,0]
    v_cvt_pk_bf16_f32 v100, v200, v201
    v_cvt_pk_bf16_f32 v101, v202, v203
    v_cvt_pk_bf16_f32 v102, v204, v205
    v_cvt_pk_bf16_f32 v103, v206, v207
    ds_write_b128 v39, v[100:103] offset:0
    v_pk_fma_f32 v[208:209], v[208:209], v[46:47], v[44:45] op_sel_hi:[1,0,0]
    v_pk_fma_f32 v[210:211], v[210:211], v[46:47], v[44:45] op_sel_hi:[1,0,0]
    v_pk_fma_f32 v[212:213], v[212:213], v[46:47], v[44:45] op_sel_hi:[1,0,0]
    v_pk_fma_f32 v[214:215], v[214:215], v[46:47], v[44:45] op_sel_hi:[1,0,0]
    v_cvt_pk_bf16_f32 v104, v208, v209
    v_cvt_pk_bf16_f32 v105, v210, v211
    v_cvt_pk_bf16_f32 v106, v212, v213
    v_cvt_pk_bf16_f32 v107, v214, v215
    ds_write_b128 v38, v[104:107] offset:32768
    v_pk_fma_f32 v[216:217], v[216:217], v[46:47], v[44:45] op_sel_hi:[1,0,0]
    v_pk_fma_f32 v[218:219], v[218:219], v[46:47], v[44:45] op_sel_hi:[1,0,0]
    v_pk_fma_f32 v[220:221], v[220:221], v[46:47], v[44:45] op_sel_hi:[1,0,0]
    v_pk_fma_f32 v[222:223], v[222:223], v[46:47], v[44:45] op_sel_hi:[1,0,0]
    v_cvt_pk_bf16_f32 v108, v216, v217
    v_cvt_pk_bf16_f32 v109, v218, v219
    v_cvt_pk_bf16_f32 v110, v220, v221
    v_cvt_pk_bf16_f32 v111, v222, v223
    ds_write_b128 v39, v[108:111] offset:32768
    v_pk_fma_f32 v[224:225], v[224:225], v[46:47], v[44:45] op_sel_hi:[1,0,0]
    v_pk_fma_f32 v[226:227], v[226:227], v[46:47], v[44:45] op_sel_hi:[1,0,0]
    v_pk_fma_f32 v[228:229], v[228:229], v[46:47], v[44:45] op_sel_hi:[1,0,0]
    v_pk_fma_f32 v[230:231], v[230:231], v[46:47], v[44:45] op_sel_hi:[1,0,0]
    v_cvt_pk_bf16_f32 v112, v224, v225
    v_cvt_pk_bf16_f32 v113, v226, v227
    v_cvt_pk_bf16_f32 v114, v228, v229
    v_cvt_pk_bf16_f32 v115, v230, v231
    ds_write_b128 v36, v[112:115] offset:0
    v_pk_fma_f32 v[232:233], v[232:233], v[46:47], v[44:45] op_sel_hi:[1,0,0]
    v_pk_fma_f32 v[234:235], v[234:235], v[46:47], v[44:45] op_sel_hi:[1,0,0]
    v_pk_fma_f32 v[236:237], v[236:237], v[46:47], v[44:45] op_sel_hi:[1,0,0]
    v_pk_fma_f32 v[238:239], v[238:239], v[46:47], v[44:45] op_sel_hi:[1,0,0]
    v_cvt_pk_bf16_f32 v116, v232, v233
    v_cvt_pk_bf16_f32 v117, v234, v235
    v_cvt_pk_bf16_f32 v118, v236, v237
    v_cvt_pk_bf16_f32 v119, v238, v239
    ds_write_b128 v37, v[116:119] offset:0
    v_pk_fma_f32 v[240:241], v[240:241], v[46:47], v[44:45] op_sel_hi:[1,0,0]
    v_pk_fma_f32 v[242:243], v[242:243], v[46:47], v[44:45] op_sel_hi:[1,0,0]
    v_pk_fma_f32 v[244:245], v[244:245], v[46:47], v[44:45] op_sel_hi:[1,0,0]
    v_pk_fma_f32 v[246:247], v[246:247], v[46:47], v[44:45] op_sel_hi:[1,0,0]
    v_cvt_pk_bf16_f32 v120, v240, v241
    v_cvt_pk_bf16_f32 v121, v242, v243
    v_cvt_pk_bf16_f32 v122, v244, v245
    v_cvt_pk_bf16_f32 v123, v246, v247
    ds_write_b128 v36, v[120:123] offset:32768
    v_pk_fma_f32 v[248:249], v[248:249], v[46:47], v[44:45] op_sel_hi:[1,0,0]
    v_pk_fma_f32 v[250:251], v[250:251], v[46:47], v[44:45] op_sel_hi:[1,0,0]
    v_pk_fma_f32 v[252:253], v[252:253], v[46:47], v[44:45] op_sel_hi:[1,0,0]
    v_pk_fma_f32 v[254:255], v[254:255], v[46:47], v[44:45] op_sel_hi:[1,0,0]
    v_cvt_pk_bf16_f32 v124, v248, v249
    v_cvt_pk_bf16_f32 v125, v250, v251
    v_cvt_pk_bf16_f32 v126, v252, v253
    v_cvt_pk_bf16_f32 v127, v254, v255
    ds_write_b128 v37, v[124:127] offset:32768
    s_waitcnt lgkmcnt(0)
    s_waitcnt vmcnt(2)
    s_barrier
    s_cmp_eq_u32 s69, 1
    s_cbranch_scc1 L_tq
    s_add_u32 s71, s71, 1024
    s_add_u32 s72, s71, 1024
    ds_read_b128 v[128:131], v24 offset:0
    ds_read_b128 v[132:135], v25 offset:0
    ds_read_b128 v[136:139], v26 offset:0
    ds_read_b128 v[140:143], v27 offset:0
    ds_read_b64_tr_b16 v[48:49], v3 offset:0
    ds_read_b64_tr_b16 v[50:51], v3 offset:512
    ds_read_b64_tr_b16 v[52:53], v3 offset:2048
    ds_read_b64_tr_b16 v[54:55], v3 offset:2560
    ds_read_b64_tr_b16 v[56:57], v3 offset:4096
    ds_read_b64_tr_b16 v[58:59], v3 offset:4608
    s_waitcnt lgkmcnt(4)
    v_mfma_f32_32x32x16_bf16 v[64:79], v[48:51], v[128:131], 0
    ds_read_b128 v[144:147], v28 offset:0
    ds_read_b128 v[148:151], v29 offset:0
    ds_read_b64_tr_b16 v[60:61], v3 offset:6144
    ds_read_b64_tr_b16 v[62:63], v3 offset:6656
    s_add_u32 s87, s68, 16
    s_lshl_b32 s87, s87, 7
    s_lshl_b32 s74, s73, 1
    s_add_u32 s73, s73, s87
    s_lshl_b32 s87, s68, 6
    s_add_u32 s87, s87, 3072
    s_waitcnt lgkmcnt(6)
    v_mfma_f32_32x32x16_bf16 v[64:79], v[52:55], v[132:135], v[64:79]
    ds_read_b128 v[152:155], v30 offset:0
    ds_read_b128 v[156:159], v31 offset:0
    ds_read_b64_tr_b16 v[48:49], v3 offset:8192
    ds_read_b64_tr_b16 v[50:51], v3 offset:8704
    s_add_u32 s74, s74, s87
    v_bfe_u32 v18, v0, 4, 1
    v_lshlrev_b32 v15, 15, v18
    v_lshl_or_b32 v15, v18, 31, v15
    s_waitcnt lgkmcnt(8)
    v_mfma_f32_32x32x16_bf16 v[64:79], v[56:59], v[136:139], v[64:79]
    ds_read_b128 v[160:163], v24 offset:32768
    ds_read_b64_tr_b16 v[52:53], v3 offset:10240
    ds_read_b64_tr_b16 v[54:55], v3 offset:10752
    s_lshr_b32 s16, s64, 1
    s_and_b32 s17, s64, 1
    s_lshl_b32 s87, s27, 7
    s_lshl_b32 s88, s17, 14
    s_add_u32 s87, s87, s88
    s_lshl_b32 s88, s16, 16
    s_waitcnt lgkmcnt(7)
    v_mfma_f32_32x32x16_bf16 v[64:79], v[60:63], v[140:143], v[64:79]
    ds_read_b128 v[164:167], v25 offset:32768
    ds_read_b64_tr_b16 v[56:57], v3 offset:12288
    ds_read_b64_tr_b16 v[58:59], v3 offset:12800
    s_add_u32 s10, s87, s88
    s_add_u32 s9, s10, s88
    s_lshl_b32 s88, s88, 1
    s_add_u32 s8, s9, s88
    s_lshl_b32 s87, s26, 1
    s_add_u32 s87, s87, s17
    s_waitcnt lgkmcnt(6)
    v_mfma_f32_32x32x16_bf16 v[64:79], v[48:51], v[144:147], v[64:79]
    ds_read_b128 v[168:171], v26 offset:32768
    ds_read_b64_tr_b16 v[60:61], v3 offset:14336
    ds_read_b64_tr_b16 v[62:63], v3 offset:14848
    s_mul_i32 s87, s87, 147456
    s_lshl_b32 s88, s16, 12
    s_add_u32 s13, s87, s88
    s_add_u32 s12, s13, s88
    s_waitcnt lgkmcnt(6)
    s_waitcnt vmcnt(0)
    s_barrier
    v_mfma_f32_32x32x16_bf16 v[64:79], v[52:55], v[148:151], v[64:79]
    ds_read_b128 v[172:175], v27 offset:32768
    ds_read_b64_tr_b16 v[48:49], v3 offset:16384
    ds_read_b64_tr_b16 v[50:51], v3 offset:16896
    s_add_u32 m0, s70, 65536
    s_add_u32 s86, s71, 786432
    buffer_load_dwordx4 v10, s[32:35], s86 offen lds
    s_lshl_b32 s88, s88, 1
    s_add_u32 s11, s12, s88
    s_lshl_b32 s83, s67, 3
    s_waitcnt lgkmcnt(6)
    v_mfma_f32_32x32x16_bf16 v[64:79], v[56:59], v[152:155], v[64:79]
    ds_read_b128 v[176:179], v28 offset:32768
    ds_read_b64_tr_b16 v[52:53], v3 offset:18432
    ds_read_b64_tr_b16 v[54:55], v3 offset:18944
    s_add_u32 s83, s83, s64
    s_lshl_b32 s83, s83, 7
    s_add_u32 s83, s83, 20971520
    s_lshr_b32 s84, s26, 1
    s_lshl_b32 s84, s84, 10
    s_and_b32 s87, s26, 1
    s_waitcnt lgkmcnt(6)
    v_mfma_f32_32x32x16_bf16 v[64:79], v[60:63], v[156:159], v[64:79]
    ds_read_b128 v[180:183], v29 offset:32768
    ds_read_b64_tr_b16 v[56:57], v3 offset:20480
    ds_read_b64_tr_b16 v[58:59], v3 offset:20992
    s_lshl_b32 s87, s87, 8
    s_add_u32 s84, s84, s87
    s_add_u32 s84, s84, 20971520
    s_lshl_b32 s85, s68, 10
    s_add_u32 s85, s85, 20987904
    s_lshl_b32 s87, s67, 2
    s_waitcnt lgkmcnt(6)
    v_mfma_f32_32x32x16_bf16 v[64:79], v[48:51], v[160:163], v[64:79]
    ds_read_b128 v[184:187], v30 offset:32768
    ds_read_b64_tr_b16 v[60:61], v3 offset:22528
    ds_read_b64_tr_b16 v[62:63], v3 offset:23040
    s_add_u32 m0, s70, 66560
    s_add_u32 s86, s71, 811008
    buffer_load_dwordx4 v10, s[32:35], s86 offen lds
    s_add_u32 s87, s87, s65
    s_mul_i32 s75, s87, 147456
    v_lshrrev_b32 v16, 3, v0
    s_waitcnt lgkmcnt(6)
    v_mfma_f32_32x32x16_bf16 v[64:79], v[52:55], v[164:167], v[64:79]
    ds_read_b128 v[188:191], v31 offset:32768
    ds_read_b64_tr_b16 v[48:49], v3 offset:24576
    ds_read_b64_tr_b16 v[50:51], v3 offset:25088
    v_and_b32 v17, 7, v0
    v_bfe_u32 v18, v0, 4, 1
    v_lshlrev_b32 v18, 2, v18
    v_xor_b32 v18, v18, v17
    s_waitcnt lgkmcnt(6)
    v_mfma_f32_32x32x16_bf16 v[64:79], v[56:59], v[168:171], v[64:79]
    v_xor_b32 v24, 0x10000, v24
    v_xor_b32 v25, 0x10000, v25
    v_xor_b32 v26, 0x10000, v26
    v_xor_b32 v27, 0x10000, v27
    v_xor_b32 v28, 0x10000, v28
    v_xor_b32 v29, 0x10000, v29
    v_xor_b32 v30, 0x10000, v30
    v_xor_b32 v31, 0x10000, v31
    ds_read_b128 v[192:195], v24 offset:0
    ds_read_b64_tr_b16 v[52:53], v3 offset:26624
    ds_read_b64_tr_b16 v[54:55], v3 offset:27136
    s_add_u32 m0, s70, 81920
    s_add_u32 s86, s71, 1179648
    buffer_load_dwordx4 v10, s[32:35], s86 offen lds
    v_lshlrev_b32 v1, 10, v16
    v_lshl_add_u32 v1, v18, 4, v1
    s_waitcnt lgkmcnt(6)
    v_mfma_f32_32x32x16_bf16 v[64:79], v[60:63], v[172:175], v[64:79]
    ds_read_b128 v[196:199], v25 offset:0
    ds_read_b64_tr_b16 v[56:57], v3 offset:28672
    ds_read_b64_tr_b16 v[58:59], v3 offset:29184
    s_lshl_b32 s87, s68, 1
    s_add_u32 s87, s87, s66
    s_lshl_b32 s88, s87, 10
    s_add_u32 s76, s75, s88
    s_add_u32 s76, s76, 98304
    s_lshl_b32 s88, s87, 11
    s_waitcnt lgkmcnt(6)
    v_mfma_f32_32x32x16_bf16 v[64:79], v[48:51], v[176:179], v[64:79]
    ds_read_b128 v[200:203], v26 offset:0
    ds_read_b64_tr_b16 v[60:61], v3 offset:30720
    ds_read_b64_tr_b16 v[62:63], v3 offset:31232
    s_add_u32 m0, s70, 82944
    s_add_u32 s86, s71, 1204224
    buffer_load_dwordx4 v10, s[32:35], s86 offen lds
    s_add_u32 s75, s75, s88
    s_add_u32 s75, s75, 65536
    s_lshl_b32 s87, s68, 4
    s_waitcnt lgkmcnt(6)
    s_waitcnt vmcnt(2)
    s_barrier
    v_mfma_f32_32x32x16_bf16 v[64:79], v[52:55], v[180:183], v[64:79]
    ds_read_b128 v[204:207], v27 offset:0
    ds_read_b64_tr_b16 v[48:49], v2 offset:0
    ds_read_b64_tr_b16 v[50:51], v2 offset:512
    s_add_u32 m0, s70, 98304
    s_add_u32 s86, s72, 0
    buffer_load_dwordx4 v10, s[32:35], s86 offen lds
    s_add_u32 s87, s87, s67
    s_mul_i32 s78, s87, 4352
    s_add_u32 s78, s78, 16777216
    s_waitcnt lgkmcnt(6)
    v_mfma_f32_32x32x16_bf16 v[64:79], v[56:59], v[184:187], v[64:79]
    ds_read_b128 v[208:211], v28 offset:0
    ds_read_b64_tr_b16 v[52:53], v2 offset:2048
    ds_read_b64_tr_b16 v[54:55], v2 offset:2560
    s_and_b32 s87, s65, 1
    s_lshl_b32 s87, s87, 7
    s_add_u32 s85, s85, s87
    s_lshr_b32 s87, s65, 1
    s_lshl_b32 s87, s87, 9
    s_add_u32 s85, s85, s87
    s_waitcnt lgkmcnt(6)
    v_mfma_f32_32x32x16_bf16 v[64:79], v[60:63], v[188:191], v[64:79]
    ds_read_b128 v[212:215], v29 offset:0
    ds_read_b64_tr_b16 v[56:57], v2 offset:4096
    ds_read_b64_tr_b16 v[58:59], v2 offset:4608
    s_lshl_b32 s87, s66, 30
    s_add_u32 s85, s85, s87
    v_bfe_u32 v16, v0, 4, 1
    v_xor_b32 v8, s66, v16
    v_lshlrev_b32 v8, 5, v8
    s_waitcnt lgkmcnt(6)
    v_mfma_f32_32x32x16_bf16 v[64:79], v[48:51], v[192:195], v[64:79]
    ds_read_b128 v[216:219], v30 offset:0
    ds_read_b64_tr_b16 v[60:61], v2 offset:6144
    ds_read_b64_tr_b16 v[62:63], v2 offset:6656
    s_add_u32 m0, s70, 99328
    s_add_u32 s86, s72, 24576
    buffer_load_dwordx4 v10, s[32:35], s86 offen lds
    v_lshl_add_u32 v8, v16, 13, v8
    v_and_b32 v16, 3, v0
    s_waitcnt lgkmcnt(6)
    v_mfma_f32_32x32x16_bf16 v[64:79], v[52:55], v[196:199], v[64:79]
    ds_read_b128 v[220:223], v31 offset:0
    ds_read_b64_tr_b16 v[48:49], v2 offset:8192
    ds_read_b64_tr_b16 v[50:51], v2 offset:8704
    v_lshl_add_u32 v8, v16, 3, v8
    v_bfe_u32 v16, v0, 2, 2
    v_lshl_add_u32 v8, v16, 6, v8
    s_waitcnt lgkmcnt(6)
    v_mfma_f32_32x32x16_bf16 v[64:79], v[56:59], v[200:203], v[64:79]
    ds_read_b128 v[224:227], v24 offset:32768
    ds_read_b64_tr_b16 v[52:53], v2 offset:10240
    ds_read_b64_tr_b16 v[54:55], v2 offset:10752
    s_add_u32 m0, s70, 114688
    s_add_u32 s86, s72, 393216
    buffer_load_dwordx4 v10, s[32:35], s86 offen lds
    v_lshrrev_b32 v17, 5, v0
    v_lshl_add_u32 v8, v17, 9, v8
    s_waitcnt lgkmcnt(6)
    v_mfma_f32_32x32x16_bf16 v[64:79], v[60:63], v[204:207], v[64:79]
    ds_read_b128 v[228:231], v25 offset:32768
    ds_read_b64_tr_b16 v[56:57], v2 offset:12288
    ds_read_b64_tr_b16 v[58:59], v2 offset:12800
    v_add_u32 v8, 0x10000, v8
    v_and_b32 v16, 31, v0
    s_lshl_b32 s87, s65, 5
    v_add_u32 v16, s87, v16
    v_lshlrev_b32 v16, 4, v16
    s_waitcnt lgkmcnt(6)
    v_mfma_f32_32x32x16_bf16 v[64:79], v[48:51], v[208:211], v[64:79]
    ds_read_b128 v[232:235], v26 offset:32768
    ds_read_b64_tr_b16 v[60:61], v2 offset:14336
    ds_read_b64_tr_b16 v[62:63], v2 offset:14848
    s_add_u32 m0, s70, 115712
    s_add_u32 s86, s72, 417792
    buffer_load_dwordx4 v10, s[32:35], s86 offen lds
    v_mul_u32_u24 v17, 4224, v17
    s_mul_i32 s87, s66, 16896
    s_waitcnt lgkmcnt(6)
    s_waitcnt vmcnt(4)
    s_barrier
    v_mfma_f32_32x32x16_bf16 v[64:79], v[52:55], v[212:215], v[64:79]
    ds_read_b128 v[236:239], v27 offset:32768
    ds_read_b64_tr_b16 v[48:49], v2 offset:16384
    ds_read_b64_tr_b16 v[50:51], v2 offset:16896
    s_lshr_b32 s86, s70, 1
    s_add_u32 m0, s86, 8192
    s_lshl_b32 s86, s68, 1
    s_add_u32 s86, s86, s66
    s_lshl_b32 s86, s86, 10
    buffer_load_dwordx4 v13, s[44:47], s86 offen lds
    v_add3_u32 v14, v16, v17, s87
    s_waitcnt lgkmcnt(6)
    v_mfma_f32_32x32x16_bf16 v[64:79], v[56:59], v[216:219], v[64:79]
    ds_read_b128 v[240:243], v28 offset:32768
    ds_read_b64_tr_b16 v[52:53], v2 offset:18432
    ds_read_b64_tr_b16 v[54:55], v2 offset:18944
    v_bfe_u32 v9, v0, 2, 2
    v_lshrrev_b32 v16, 5, v0
    v_lshl_add_u32 v9, v16, 2, v9
    v_and_b32 v16, 3, v0
    s_waitcnt lgkmcnt(6)
    v_mfma_f32_32x32x16_bf16 v[64:79], v[60:63], v[220:223], v[64:79]
    ds_read_b128 v[244:247], v29 offset:32768
    ds_read_b64_tr_b16 v[56:57], v2 offset:20480
    ds_read_b64_tr_b16 v[58:59], v2 offset:20992
    v_lshlrev_b32 v16, 3, v16
    v_lshl_add_u32 v9, v9, 5, v16
    s_lshr_b32 s87, s70, 1
    s_add_u32 s87, s87, 8192
    v_add_u32 v9, s87, v9
    s_waitcnt lgkmcnt(6)
    v_mfma_f32_32x32x16_bf16 v[64:79], v[48:51], v[224:227], v[64:79]
    ds_read_b128 v[248:251], v30 offset:32768
    ds_read_b64_tr_b16 v[60:61], v2 offset:22528
    ds_read_b64_tr_b16 v[62:63], v2 offset:23040
    s_add_u32 m0, s70, 131072
    s_add_u32 s86, s72, 786432
    buffer_load_dwordx4 v10, s[32:35], s86 offen lds
    s_waitcnt lgkmcnt(6)
    v_mfma_f32_32x32x16_bf16 v[64:79], v[52:55], v[228:231], v[64:79]
    ds_read_b128 v[252:255], v31 offset:32768
    ds_read_b64_tr_b16 v[48:49], v2 offset:24576
    ds_read_b64_tr_b16 v[50:51], v2 offset:25088
    s_waitcnt lgkmcnt(6)
    v_mfma_f32_32x32x16_bf16 v[64:79], v[56:59], v[232:235], v[64:79]
    ds_read_b64_tr_b16 v[52:53], v2 offset:26624
    ds_read_b64_tr_b16 v[54:55], v2 offset:27136
    s_add_u32 m0, s70, 132096
    s_add_u32 s86, s72, 811008
    buffer_load_dwordx4 v10, s[32:35], s86 offen lds
    s_waitcnt lgkmcnt(5)
    v_mfma_f32_32x32x16_bf16 v[64:79], v[60:63], v[236:239], v[64:79]
    ds_read_b64_tr_b16 v[56:57], v2 offset:28672
    ds_read_b64_tr_b16 v[58:59], v2 offset:29184
    s_waitcnt lgkmcnt(4)
    v_mfma_f32_32x32x16_bf16 v[64:79], v[48:51], v[240:243], v[64:79]
    ds_read_b64_tr_b16 v[60:61], v2 offset:30720
    ds_read_b64_tr_b16 v[62:63], v2 offset:31232
    s_waitcnt lgkmcnt(4)
    s_waitcnt vmcnt(5)
    s_barrier
    v_mfma_f32_32x32x16_bf16 v[64:79], v[52:55], v[244:247], v[64:79]
    ds_read_b64_tr_b16 v[48:49], v2 offset:32768
    ds_read_b64_tr_b16 v[50:51], v2 offset:33280
    s_add_u32 m0, s70, 147456
    s_add_u32 s86, s72, 1179648
    buffer_load_dwordx4 v10, s[32:35], s86 offen lds
    s_waitcnt vmcnt(3)
    ds_read_b64_tr_b16 v[20:21], v9 offset:0
    ds_read_b64_tr_b16 v[22:23], v9 offset:256
    v_mov_b32 v112, 0x3f803f80
    v_mov_b32 v113, 0x3f803f80
    v_lshlrev_b32 v114, 3, v0
    v_and_b32 v114, 8, v114
    ds_write_b64 v114, v[112:113] offset:58368
    s_waitcnt lgkmcnt(7)
    v_mfma_f32_32x32x16_bf16 v[64:79], v[56:59], v[248:251], v[64:79]
    ds_read_b64_tr_b16 v[52:53], v2 offset:34816
    ds_read_b64_tr_b16 v[54:55], v2 offset:35328
    s_waitcnt lgkmcnt(7)
    v_mfma_f32_32x32x16_bf16 v[64:79], v[60:63], v[252:255], v[64:79]
    ds_read_b64_tr_b16 v[56:57], v2 offset:36864
    ds_read_b64_tr_b16 v[58:59], v2 offset:37376
    s_waitcnt lgkmcnt(6)
    v_xor_b32 v20, v15, v20
    v_xor_b32 v21, v15, v21
    s_waitcnt lgkmcnt(5)
    v_xor_b32 v22, v15, v22
    v_xor_b32 v23, v15, v23
    v_mfma_f32_32x32x16_bf16 v[80:95], v[128:131], v[48:51], 0
    ds_read_b64_tr_b16 v[60:61], v2 offset:38912
    ds_read_b64_tr_b16 v[62:63], v2 offset:39424
    s_add_u32 m0, s70, 148480
    s_add_u32 s86, s72, 1204224
    buffer_load_dwordx4 v10, s[32:35], s86 offen lds
    s_waitcnt lgkmcnt(4)
    v_mfma_f32_32x32x16_bf16 v[80:95], v[132:135], v[52:55], v[80:95]
    ds_read_b64_tr_b16 v[48:49], v2 offset:40960
    ds_read_b64_tr_b16 v[50:51], v2 offset:41472
    v_cvt_pk_bf16_f32 v24, v64, v65
    v_cvt_pk_bf16_f32 v25, v66, v67
    v_cvt_pk_bf16_f32 v26, v68, v69
    v_cvt_pk_bf16_f32 v27, v70, v71
    v_cvt_pk_bf16_f32 v28, v72, v73
    s_waitcnt lgkmcnt(4)
    v_mfma_f32_32x32x16_bf16 v[80:95], v[136:139], v[56:59], v[80:95]
    ds_read_b64_tr_b16 v[52:53], v2 offset:43008
    ds_read_b64_tr_b16 v[54:55], v2 offset:43520
    s_add_u32 m0, s70, 65536
    s_add_u32 s86, s73, 0
    buffer_load_dwordx4 v11, s[36:39], s86 offen lds
    v_cvt_pk_bf16_f32 v29, v74, v75
    v_cvt_pk_bf16_f32 v30, v76, v77
    v_cvt_pk_bf16_f32 v31, v78, v79
    s_waitcnt lgkmcnt(4)
    v_mfma_f32_32x32x16_bf16 v[80:95], v[140:143], v[60:63], v[80:95]
    ds_read_b64_tr_b16 v[56:57], v2 offset:45056
    ds_read_b64_tr_b16 v[58:59], v2 offset:45568
    v_mfma_f32_32x32x16_bf16 v[32:47], v[20:23], v[24:27], 0
    s_waitcnt lgkmcnt(4)
    v_mfma_f32_32x32x16_bf16 v[80:95], v[144:147], v[48:51], v[80:95]
    ds_read_b64_tr_b16 v[60:61], v2 offset:47104
    ds_read_b64_tr_b16 v[62:63], v2 offset:47616
    s_waitcnt lgkmcnt(4)
    s_barrier
    v_mfma_f32_32x32x16_bf16 v[80:95], v[148:151], v[52:55], v[80:95]
    ds_read_b64_tr_b16 v[48:49], v2 offset:49152
    ds_read_b64_tr_b16 v[50:51], v2 offset:49664
    s_add_u32 m0, s70, 66560
    s_add_u32 s86, s73, 28672
    buffer_load_dwordx4 v11, s[36:39], s86 offen lds
    ds_read_b64_tr_b16 v[20:21], v9 offset:512
    ds_read_b64_tr_b16 v[22:23], v9 offset:768
    v_max3_f32 v16, v32, v33, v34
    s_waitcnt lgkmcnt(6)
    v_mfma_f32_32x32x16_bf16 v[80:95], v[152:155], v[56:59], v[80:95]
    ds_read_b64_tr_b16 v[52:53], v2 offset:51200
    ds_read_b64_tr_b16 v[54:55], v2 offset:51712
    v_max3_f32 v17, v40, v41, v42
    v_max3_f32 v16, v16, v35, v36
    v_max3_f32 v17, v17, v43, v44
    v_max3_f32 v16, v16, v37, v38
    s_waitcnt lgkmcnt(6)
    v_mfma_f32_32x32x16_bf16 v[80:95], v[156:159], v[60:63], v[80:95]
    ds_read_b64_tr_b16 v[56:57], v2 offset:53248
    ds_read_b64_tr_b16 v[58:59], v2 offset:53760
    v_max3_f32 v17, v17, v45, v46
    v_max_f32 v16, v16, v39
    v_max_f32 v17, v17, v47
    s_nop 1
    v_permlane32_swap_b32 v16, v17
    v_max_f32 v16, v16, v17
    s_waitcnt lgkmcnt(6)
    v_mfma_f32_32x32x16_bf16 v[80:95], v[160:163], v[48:51], v[80:95]
    ds_read_b64_tr_b16 v[60:61], v2 offset:55296
    ds_read_b64_tr_b16 v[62:63], v2 offset:55808
    s_add_u32 m0, s70, 81920
    s_add_u32 s86, s73, 229376
    buffer_load_dwordx4 v11, s[36:39], s86 offen lds
    v_mul_f32 v16, s80, v16
    v_mov_b32 v17, v16
    s_nop 1
    v_permlane32_swap_b32 v16, v17
    s_waitcnt lgkmcnt(4)
    v_mfma_f32_32x32x16_bf16 v[80:95], v[164:167], v[52:55], v[80:95]
    ds_read_b64_tr_b16 v[48:49], v2 offset:57344
    ds_read_b64_tr_b16 v[50:51], v2 offset:57856
    v_fma_f32 v32, v32, s79, v16
    v_fma_f32 v40, v40, s79, v17
    v_fma_f32 v33, v33, s79, v16
    v_fma_f32 v41, v41, s79, v17
    s_waitcnt lgkmcnt(4)
    v_mfma_f32_32x32x16_bf16 v[80:95], v[168:171], v[56:59], v[80:95]
    ds_read_b64_tr_b16 v[52:53], v2 offset:59392
    ds_read_b64_tr_b16 v[54:55], v2 offset:59904
    s_add_u32 m0, s70, 82944
    s_add_u32 s86, s73, 258048
    buffer_load_dwordx4 v11, s[36:39], s86 offen lds
    v_fma_f32 v34, v34, s79, v16
    v_fma_f32 v42, v42, s79, v17
    s_waitcnt lgkmcnt(4)
    v_mfma_f32_32x32x16_bf16 v[80:95], v[172:175], v[60:63], v[80:95]
    ds_read_b64_tr_b16 v[56:57], v2 offset:61440
    ds_read_b64_tr_b16 v[58:59], v2 offset:61952
    v_fma_f32 v35, v35, s79, v16
    v_xor_b32 v20, v15, v20
    v_xor_b32 v21, v15, v21
    v_xor_b32 v22, v15, v22
    v_xor_b32 v23, v15, v23
    s_waitcnt lgkmcnt(4)
    v_mfma_f32_32x32x16_bf16 v[80:95], v[176:179], v[48:51], v[80:95]
    ds_read_b64_tr_b16 v[60:61], v2 offset:63488
    ds_read_b64_tr_b16 v[62:63], v2 offset:64000
    v_fma_f32 v43, v43, s79, v17
    v_fma_f32 v36, v36, s79, v16
    s_waitcnt lgkmcnt(4)
    s_waitcnt vmcnt(6)
    s_barrier
    v_mfma_f32_32x32x16_bf16 v[80:95], v[180:183], v[52:55], v[80:95]
    ds_read_b64_tr_b16 v[48:49], v3 offset:0
    ds_read_b64_tr_b16 v[50:51], v3 offset:512
    s_add_u32 m0, s70, 98304
    s_add_u32 s86, s73, 458752
    buffer_load_dwordx4 v11, s[36:39], s86 offen lds
    v_fma_f32 v44, v44, s79, v17
    v_fma_f32 v37, v37, s79, v16
    s_waitcnt lgkmcnt(4)
    v_mfma_f32_32x32x16_bf16 v[80:95], v[184:187], v[56:59], v[80:95]
    ds_read_b64_tr_b16 v[52:53], v3 offset:2048
    ds_read_b64_tr_b16 v[54:55], v3 offset:2560
    v_fma_f32 v45, v45, s79, v17
    v_fma_f32 v38, v38, s79, v16
    v_fma_f32 v46, v46, s79, v17
    v_fma_f32 v39, v39, s79, v16
    s_waitcnt lgkmcnt(4)
    v_mfma_f32_32x32x16_bf16 v[80:95], v[188:191], v[60:63], v[80:95]
    ds_read_b64_tr_b16 v[56:57], v3 offset:4096
    ds_read_b64_tr_b16 v[58:59], v3 offset:4608
    v_fma_f32 v47, v47, s79, v17
    v_exp_f32 v32, v32
    v_exp_f32 v40, v40
    s_waitcnt lgkmcnt(4)
    v_mfma_f32_32x32x16_bf16 v[80:95], v[192:195], v[48:51], v[80:95]
    ds_read_b64_tr_b16 v[60:61], v3 offset:6144
    ds_read_b64_tr_b16 v[62:63], v3 offset:6656
    s_add_u32 m0, s70, 99328
    s_add_u32 s86, s73, 487424
    buffer_load_dwordx4 v11, s[36:39], s86 offen lds
    v_exp_f32 v33, v33
    s_waitcnt lgkmcnt(4)
    v_mfma_f32_32x32x16_bf16 v[80:95], v[196:199], v[52:55], v[80:95]
    ds_read_b64_tr_b16 v[48:49], v3 offset:8192
    ds_read_b64_tr_b16 v[50:51], v3 offset:8704
    v_exp_f32 v41, v41
    v_exp_f32 v34, v34
    v_add_f32 v18, v32, v33
    s_waitcnt lgkmcnt(4)
    v_mfma_f32_32x32x16_bf16 v[80:95], v[200:203], v[56:59], v[80:95]
    ds_read_b64_tr_b16 v[52:53], v3 offset:10240
    ds_read_b64_tr_b16 v[54:55], v3 offset:10752
    v_exp_f32 v42, v42
    v_add_f32 v19, v40, v41
    v_exp_f32 v35, v35
    v_add_f32 v18, v18, v34
    s_waitcnt lgkmcnt(4)
    v_mfma_f32_32x32x16_bf16 v[80:95], v[204:207], v[60:63], v[80:95]
    ds_read_b64_tr_b16 v[56:57], v3 offset:12288
    ds_read_b64_tr_b16 v[58:59], v3 offset:12800
    v_exp_f32 v43, v43
    v_add_f32 v19, v19, v42
    v_exp_f32 v36, v36
    v_add_f32 v18, v18, v35
    s_waitcnt lgkmcnt(4)
    v_mfma_f32_32x32x16_bf16 v[80:95], v[208:211], v[48:51], v[80:95]
    ds_read_b64_tr_b16 v[60:61], v3 offset:14336
    ds_read_b64_tr_b16 v[62:63], v3 offset:14848
    v_exp_f32 v44, v44
    v_add_f32 v19, v19, v43
    s_waitcnt lgkmcnt(4)
    s_waitcnt vmcnt(6)
    s_barrier
    v_mfma_f32_32x32x16_bf16 v[80:95], v[212:215], v[52:55], v[80:95]
    ds_read_b64_tr_b16 v[48:49], v3 offset:16384
    ds_read_b64_tr_b16 v[50:51], v3 offset:16896
    s_add_u32 m0, s70, 114688
    s_add_u32 s86, s73, 688128
    buffer_load_dwordx4 v11, s[36:39], s86 offen lds
    v_exp_f32 v37, v37
    v_add_f32 v18, v18, v36
    s_waitcnt lgkmcnt(4)
    v_mfma_f32_32x32x16_bf16 v[80:95], v[216:219], v[56:59], v[80:95]
    ds_read_b64_tr_b16 v[52:53], v3 offset:18432
    ds_read_b64_tr_b16 v[54:55], v3 offset:18944
    v_exp_f32 v45, v45
    v_add_f32 v19, v19, v44
    v_exp_f32 v38, v38
    v_add_f32 v18, v18, v37
    s_waitcnt lgkmcnt(4)
    v_mfma_f32_32x32x16_bf16 v[80:95], v[220:223], v[60:63], v[80:95]
    ds_read_b64_tr_b16 v[56:57], v3 offset:20480
    ds_read_b64_tr_b16 v[58:59], v3 offset:20992
    v_exp_f32 v46, v46
    v_add_f32 v19, v19, v45
    v_exp_f32 v39, v39
    v_add_f32 v18, v18, v38
    s_waitcnt lgkmcnt(4)
    v_mfma_f32_32x32x16_bf16 v[80:95], v[224:227], v[48:51], v[80:95]
    ds_read_b64_tr_b16 v[60:61], v3 offset:22528
    ds_read_b64_tr_b16 v[62:63], v3 offset:23040
    s_add_u32 m0, s70, 115712
    s_add_u32 s86, s73, 716800
    buffer_load_dwordx4 v11, s[36:39], s86 offen lds
    v_exp_f32 v47, v47
    v_add_f32 v19, v19, v46
    s_waitcnt lgkmcnt(4)
    v_mfma_f32_32x32x16_bf16 v[80:95], v[228:231], v[52:55], v[80:95]
    ds_read_b64_tr_b16 v[48:49], v3 offset:24576
    ds_read_b64_tr_b16 v[50:51], v3 offset:25088
    v_add_f32 v18, v18, v39
    v_add_f32 v19, v19, v47
    s_nop 1
    v_permlane32_swap_b32 v18, v19
    v_add_f32 v18, v18, v19
    v_rcp_f32 v18, v18
    s_waitcnt lgkmcnt(4)
    v_mfma_f32_32x32x16_bf16 v[80:95], v[232:235], v[56:59], v[80:95]
    ds_read_b64_tr_b16 v[52:53], v3 offset:26624
    ds_read_b64_tr_b16 v[54:55], v3 offset:27136
    v_mov_b32 v19, v18
    s_nop 1
    v_permlane32_swap_b32 v18, v19
    v_mul_f32 v32, v32, v18
    v_mul_f32 v33, v33, v18
    v_mul_f32 v34, v34, v18
    v_mul_f32 v35, v35, v18
    s_waitcnt lgkmcnt(4)
    v_mfma_f32_32x32x16_bf16 v[80:95], v[236:239], v[60:63], v[80:95]
    ds_read_b64_tr_b16 v[56:57], v3 offset:28672
    ds_read_b64_tr_b16 v[58:59], v3 offset:29184
    v_mul_f32 v36, v36, v18
    v_mul_f32 v37, v37, v18
    v_mul_f32 v38, v38, v18
    v_mul_f32 v39, v39, v18
    v_cvt_pk_bf16_f32 v24, v32, v33
    s_waitcnt lgkmcnt(4)
    v_mfma_f32_32x32x16_bf16 v[80:95], v[240:243], v[48:51], v[80:95]
    ds_read_b64_tr_b16 v[60:61], v3 offset:30720
    ds_read_b64_tr_b16 v[62:63], v3 offset:31232
    v_cvt_pk_bf16_f32 v25, v34, v35
    v_cvt_pk_bf16_f32 v26, v36, v37
    s_waitcnt lgkmcnt(4)
    s_waitcnt vmcnt(6)
    s_barrier
    v_mfma_f32_32x32x16_bf16 v[80:95], v[244:247], v[52:55], v[80:95]
    ds_read_b64_tr_b16 v[48:49], v4 offset:0
    ds_read_b64_tr_b16 v[50:51], v4 offset:512
    s_add_u32 m0, s70, 131072
    s_add_u32 s86, s73, 917504
    buffer_load_dwordx4 v11, s[36:39], s86 offen lds
    v_cvt_pk_bf16_f32 v27, v38, v39
    s_waitcnt lgkmcnt(4)
    v_mfma_f32_32x32x16_bf16 v[80:95], v[248:251], v[56:59], v[80:95]
    ds_read_b64_tr_b16 v[52:53], v4 offset:2048
    ds_read_b64_tr_b16 v[54:55], v4 offset:2560
    ds_write_b128 v14, v[24:27] offset:0
    v_mul_f32 v40, v40, v19
    v_mul_f32 v41, v41, v19
    v_mul_f32 v42, v42, v19
    s_waitcnt lgkmcnt(5)
    v_mfma_f32_32x32x16_bf16 v[80:95], v[252:255], v[60:63], v[80:95]
    ds_read_b64_tr_b16 v[56:57], v4 offset:4096
    ds_read_b64_tr_b16 v[58:59], v4 offset:4608
    v_mul_f32 v43, v43, v19
    v_mul_f32 v44, v44, v19
    v_mul_f32 v45, v45, v19
    v_mul_f32 v46, v46, v19
    v_mul_f32 v47, v47, v19
    s_waitcnt lgkmcnt(5)
    v_mfma_f32_32x32x16_bf16 v[64:79], v[48:51], v[128:131], 0
    ds_read_b64_tr_b16 v[60:61], v4 offset:6144
    ds_read_b64_tr_b16 v[62:63], v4 offset:6656
    s_add_u32 m0, s70, 132096
    s_add_u32 s86, s73, 946176
    buffer_load_dwordx4 v11, s[36:39], s86 offen lds
    v_cvt_pk_bf16_f32 v24, v40, v41
    v_cvt_pk_bf16_f32 v25, v42, v43
    v_cvt_pk_bf16_f32 v26, v44, v45
    s_waitcnt lgkmcnt(5)
    v_mfma_f32_32x32x16_bf16 v[64:79], v[52:55], v[132:135], v[64:79]
    ds_read_b64_tr_b16 v[48:49], v6 offset:0
    ds_read_b64_tr_b16 v[50:51], v6 offset:512
    v_cvt_pk_bf16_f32 v27, v46, v47
    ds_write_b128 v14, v[24:27] offset:2112
    v_mfma_f32_32x32x16_bf16 v[32:47], v[20:23], v[28:31], 0
    s_waitcnt lgkmcnt(5)
    v_mfma_f32_32x32x16_bf16 v[64:79], v[56:59], v[136:139], v[64:79]
    ds_read_b64_tr_b16 v[52:53], v6 offset:2048
    ds_read_b64_tr_b16 v[54:55], v6 offset:2560
    s_add_u32 s87, s70, 33792
    v_add_u32 v18, s87, v13
    v_cvt_pk_bf16_f32 v24, v80, v81
    v_cvt_pk_bf16_f32 v25, v82, v83
    v_cvt_pk_bf16_f32 v26, v84, v85
    s_waitcnt lgkmcnt(5)
    v_mfma_f32_32x32x16_bf16 v[64:79], v[60:63], v[140:143], v[64:79]
    ds_read_b64_tr_b16 v[56:57], v6 offset:4096
    ds_read_b64_tr_b16 v[58:59], v6 offset:4608
    v_cvt_pk_bf16_f32 v27, v86, v87
    ds_write_b128 v18, v[24:27] offset:0
    v_cvt_pk_bf16_f32 v28, v88, v89
    v_cvt_pk_bf16_f32 v29, v90, v91
    s_waitcnt lgkmcnt(6)
    v_mfma_f32_32x32x16_bf16 v[96:111], v[48:51], v[128:131], 0
    ds_read_b64_tr_b16 v[60:61], v6 offset:6144
    ds_read_b64_tr_b16 v[62:63], v6 offset:6656
    v_cvt_pk_bf16_f32 v30, v92, v93
    v_cvt_pk_bf16_f32 v31, v94, v95
    s_waitcnt lgkmcnt(5)
    s_waitcnt vmcnt(6)
    s_barrier
    v_mfma_f32_32x32x16_bf16 v[96:111], v[52:55], v[132:135], v[96:111]
    ds_read_b64_tr_b16 v[48:49], v4 offset:16384
    ds_read_b64_tr_b16 v[50:51], v4 offset:16896
    s_add_u32 m0, s70, 147456
    s_add_u32 s86, s73, 1146880
    buffer_load_dwordx4 v11, s[36:39], s86 offen lds
    v_add_u32 v9, 0x10000, v8
    v_lshrrev_b32 v19, 2, v0
    v_mul_u32_u24 v10, 3584, v19
    s_waitcnt lgkmcnt(5)
    v_mfma_f32_32x32x16_bf16 v[96:111], v[56:59], v[136:139], v[96:111]
    ds_read_b64_tr_b16 v[52:53], v6 offset:16384
    ds_read_b64_tr_b16 v[54:55], v6 offset:16896
    ds_write_b128 v18, v[28:31] offset:1024
    v_and_b32 v19, 3, v0
    s_lshl_b32 s87, s66, 1
    v_xor_b32 v19, s87, v19
    s_waitcnt lgkmcnt(5)
    v_mfma_f32_32x32x16_bf16 v[96:111], v[60:63], v[140:143], v[96:111]
    ds_read_b64_tr_b16 v[56:57], v4 offset:18432
    ds_read_b64_tr_b16 v[58:59], v4 offset:18944
    v_lshl_add_u32 v10, v19, 4, v10
    v_max3_f32 v16, v32, v33, v34
    v_max3_f32 v17, v40, v41, v42
    v_max3_f32 v16, v16, v35, v36
    v_lshlrev_b32 v123, 24, v0
    s_mov_b32 s20, 0
    s_cmp_lg_u32 s64, 0
    s_cbranch_scc1 L_nos_1
    buffer_load_dword v124, v123, s[48:51], s20 offen offset:0 sc1
L_nos_1:
    s_waitcnt lgkmcnt(5)
    v_mfma_f32_32x32x16_bf16 v[64:79], v[48:51], v[144:147], v[64:79]
    ds_read_b64_tr_b16 v[60:61], v6 offset:18432
    ds_read_b64_tr_b16 v[62:63], v6 offset:18944
    s_add_u32 m0, s70, 148480
    s_add_u32 s86, s73, 1175552
    buffer_load_dwordx4 v11, s[36:39], s86 offen lds
    v_max3_f32 v17, v17, v43, v44
    v_max3_f32 v16, v16, v37, v38
    s_waitcnt lgkmcnt(5)
    v_mfma_f32_32x32x16_bf16 v[96:111], v[52:55], v[144:147], v[96:111]
    ds_read_b64_tr_b16 v[48:49], v4 offset:20480
    ds_read_b64_tr_b16 v[50:51], v4 offset:20992
    v_max3_f32 v17, v17, v45, v46
    v_max_f32 v16, v16, v39
    v_max_f32 v17, v17, v47
    s_nop 1
    v_permlane32_swap_b32 v16, v17
    v_max_f32 v16, v16, v17
    s_waitcnt lgkmcnt(4)
    v_mfma_f32_32x32x16_bf16 v[64:79], v[56:59], v[148:151], v[64:79]
    ds_read_b64_tr_b16 v[52:53], v6 offset:20480
    ds_read_b64_tr_b16 v[54:55], v6 offset:20992
    v_mul_f32 v16, s80, v16
    v_mov_b32 v17, v16
    s_nop 1
    v_permlane32_swap_b32 v16, v17
    v_fma_f32 v32, v32, s79, v16
    v_fma_f32 v40, v40, s79, v17
    s_waitcnt lgkmcnt(4)
    v_mfma_f32_32x32x16_bf16 v[96:111], v[60:63], v[148:151], v[96:111]
    ds_read_b64_tr_b16 v[56:57], v4 offset:22528
    ds_read_b64_tr_b16 v[58:59], v4 offset:23040
    v_fma_f32 v33, v33, s79, v16
    v_fma_f32 v41, v41, s79, v17
    v_fma_f32 v34, v34, s79, v16
    v_fma_f32 v42, v42, s79, v17
    s_waitcnt lgkmcnt(4)
    v_mfma_f32_32x32x16_bf16 v[64:79], v[48:51], v[152:155], v[64:79]
    ds_read_b64_tr_b16 v[60:61], v6 offset:22528
    ds_read_b64_tr_b16 v[62:63], v6 offset:23040
    v_fma_f32 v35, v35, s79, v16
    v_fma_f32 v43, v43, s79, v17
    s_waitcnt lgkmcnt(4)
    s_waitcnt vmcnt(6)
    s_barrier
    v_mfma_f32_32x32x16_bf16 v[96:111], v[52:55], v[152:155], v[96:111]
    ds_read_b64_tr_b16 v[48:49], v4 offset:32768
    ds_read_b64_tr_b16 v[50:51], v4 offset:33280
    s_add_u32 m0, s70, 65536
    s_add_u32 s86, s73, 1376256
    buffer_load_dwordx4 v11, s[36:39], s86 offen lds
    v_fma_f32 v36, v36, s79, v16
    v_fma_f32 v44, v44, s79, v17
    s_waitcnt lgkmcnt(4)
    v_mfma_f32_32x32x16_bf16 v[64:79], v[56:59], v[156:159], v[64:79]
    ds_read_b64_tr_b16 v[52:53], v6 offset:32768
    ds_read_b64_tr_b16 v[54:55], v6 offset:33280
    v_fma_f32 v37, v37, s79, v16
    v_fma_f32 v45, v45, s79, v17
    v_fma_f32 v38, v38, s79, v16
    v_fma_f32 v46, v46, s79, v17
    s_waitcnt lgkmcnt(4)
    v_mfma_f32_32x32x16_bf16 v[96:111], v[60:63], v[156:159], v[96:111]
    ds_read_b64_tr_b16 v[56:57], v4 offset:34816
    ds_read_b64_tr_b16 v[58:59], v4 offset:35328
    v_fma_f32 v39, v39, s79, v16
    v_fma_f32 v47, v47, s79, v17
    v_exp_f32 v32, v32
    s_waitcnt lgkmcnt(4)
    v_mfma_f32_32x32x16_bf16 v[64:79], v[48:51], v[160:163], v[64:79]
    ds_read_b64_tr_b16 v[60:61], v6 offset:34816
    ds_read_b64_tr_b16 v[62:63], v6 offset:35328
    s_add_u32 m0, s70, 66560
    s_add_u32 s86, s73, 1404928
    buffer_load_dwordx4 v11, s[36:39], s86 offen lds
    v_exp_f32 v40, v40
    s_waitcnt lgkmcnt(4)
    v_mfma_f32_32x32x16_bf16 v[96:111], v[52:55], v[160:163], v[96:111]
    ds_read_b64_tr_b16 v[48:49], v4 offset:36864
    ds_read_b64_tr_b16 v[50:51], v4 offset:37376
    v_exp_f32 v33, v33
    v_exp_f32 v41, v41
    v_exp_f32 v34, v34
    s_waitcnt lgkmcnt(4)
    v_mfma_f32_32x32x16_bf16 v[64:79], v[56:59], v[164:167], v[64:79]
    ds_read_b64_tr_b16 v[52:53], v6 offset:36864
    ds_read_b64_tr_b16 v[54:55], v6 offset:37376
    v_add_f32 v18, v32, v33
    v_exp_f32 v42, v42
    v_add_f32 v19, v40, v41
    v_exp_f32 v35, v35
    s_waitcnt lgkmcnt(4)
    v_mfma_f32_32x32x16_bf16 v[96:111], v[60:63], v[164:167], v[96:111]
    ds_read_b64_tr_b16 v[56:57], v4 offset:38912
    ds_read_b64_tr_b16 v[58:59], v4 offset:39424
    v_add_f32 v18, v18, v34
    v_exp_f32 v43, v43
    v_add_f32 v19, v19, v42
    v_exp_f32 v36, v36
    s_waitcnt lgkmcnt(4)
    v_mfma_f32_32x32x16_bf16 v[64:79], v[48:51], v[168:171], v[64:79]
    ds_read_b64_tr_b16 v[60:61], v6 offset:38912
    ds_read_b64_tr_b16 v[62:63], v6 offset:39424
    v_add_f32 v18, v18, v35
    v_exp_f32 v44, v44
    s_waitcnt lgkmcnt(4)
    s_waitcnt vmcnt(6)
    s_barrier
    v_mfma_f32_32x32x16_bf16 v[96:111], v[52:55], v[168:171], v[96:111]
    ds_read_b64_tr_b16 v[48:49], v4 offset:49152
    ds_read_b64_tr_b16 v[50:51], v4 offset:49664
    s_add_u32 m0, s70, 81920
    s_add_u32 s86, s73, 1605632
    buffer_load_dwordx4 v11, s[36:39], s86 offen lds
    v_add_f32 v19, v19, v43
    v_exp_f32 v37, v37
    s_waitcnt lgkmcnt(4)
    v_mfma_f32_32x32x16_bf16 v[64:79], v[56:59], v[172:175], v[64:79]
    ds_read_b64_tr_b16 v[52:53], v6 offset:49152
    ds_read_b64_tr_b16 v[54:55], v6 offset:49664
    v_add_f32 v18, v18, v36
    v_exp_f32 v45, v45
    v_add_f32 v19, v19, v44
    v_exp_f32 v38, v38
    s_waitcnt lgkmcnt(4)
    v_mfma_f32_32x32x16_bf16 v[96:111], v[60:63], v[172:175], v[96:111]
    ds_read_b64_tr_b16 v[56:57], v4 offset:51200
    ds_read_b64_tr_b16 v[58:59], v4 offset:51712
    v_add_f32 v18, v18, v37
    v_exp_f32 v46, v46
    v_add_f32 v19, v19, v45
    v_exp_f32 v39, v39
    s_waitcnt lgkmcnt(4)
    v_mfma_f32_32x32x16_bf16 v[64:79], v[48:51], v[176:179], v[64:79]
    ds_read_b64_tr_b16 v[60:61], v6 offset:51200
    ds_read_b64_tr_b16 v[62:63], v6 offset:51712
    s_add_u32 m0, s70, 82944
    s_add_u32 s86, s73, 1634304
    buffer_load_dwordx4 v11, s[36:39], s86 offen lds
    v_add_f32 v18, v18, v38
    v_exp_f32 v47, v47
    s_waitcnt lgkmcnt(4)
    v_mfma_f32_32x32x16_bf16 v[96:111], v[52:55], v[176:179], v[96:111]
    ds_read_b64_tr_b16 v[48:49], v4 offset:53248
    ds_read_b64_tr_b16 v[50:51], v4 offset:53760
    v_add_f32 v19, v19, v46
    v_add_f32 v18, v18, v39
    v_add_f32 v19, v19, v47
    s_nop 1
    v_permlane32_swap_b32 v18, v19
    v_add_f32 v18, v18, v19
    s_waitcnt lgkmcnt(4)
    v_mfma_f32_32x32x16_bf16 v[64:79], v[56:59], v[180:183], v[64:79]
    ds_read_b64_tr_b16 v[52:53], v6 offset:53248
    ds_read_b64_tr_b16 v[54:55], v6 offset:53760
    v_rcp_f32 v18, v18
    s_nop 0
    v_mov_b32 v19, v18
    s_nop 1
    v_permlane32_swap_b32 v18, v19
    v_mul_f32 v32, v32, v18
    v_mul_f32 v33, v33, v18
    s_waitcnt lgkmcnt(4)
    v_mfma_f32_32x32x16_bf16 v[96:111], v[60:63], v[180:183], v[96:111]
    ds_read_b64_tr_b16 v[56:57], v4 offset:55296
    ds_read_b64_tr_b16 v[58:59], v4 offset:55808
    v_mul_f32 v34, v34, v18
    v_mul_f32 v35, v35, v18
    v_mul_f32 v36, v36, v18
    v_mul_f32 v37, v37, v18
    v_mul_f32 v38, v38, v18
    v_mul_f32 v39, v39, v18
    s_waitcnt lgkmcnt(4)
    v_mfma_f32_32x32x16_bf16 v[64:79], v[48:51], v[184:187], v[64:79]
    ds_read_b64_tr_b16 v[60:61], v6 offset:55296
    ds_read_b64_tr_b16 v[62:63], v6 offset:55808
    v_cvt_pk_bf16_f32 v24, v32, v33
    v_cvt_pk_bf16_f32 v25, v34, v35
    s_waitcnt lgkmcnt(4)
    s_cmp_lg_u32 s64, 0
    s_cbranch_scc1 L_ok_2
    s_waitcnt vmcnt(5)
    v_cmp_gt_u32 vcc, 1, v124
    s_nop 0
    s_mov_b32 s92, vcc_lo
    s_and_b32 s92, s92, 1
    s_cbranch_scc0 L_ok_2
    s_mov_b32 s91, 0
L_spin_3:
    buffer_load_dword v124, v123, s[48:51], s20 offen offset:0 sc1
    s_add_u32 s91, s91, 1
    s_cmp_ge_u32 s91, 0x80000
    s_cbranch_scc1 L_ok_2
    s_waitcnt vmcnt(0)

    v_cmp_gt_u32 vcc, 1, v124
    s_nop 0
    s_mov_b32 s92, vcc_lo
    s_and_b32 s92, s92, 1
    s_cbranch_scc1 L_spin_3
L_ok_2:
    s_waitcnt vmcnt(6)
    s_barrier
    v_mfma_f32_32x32x16_bf16 v[96:111], v[52:55], v[184:187], v[96:111]
    ds_read_b64_tr_b16 v[48:49], v5 offset:0
    ds_read_b64_tr_b16 v[50:51], v5 offset:512
    s_add_u32 m0, s70, 98304
    s_add_u32 s86, s74, 0
    buffer_load_dwordx4 v10, s[36:39], s86 offen lds
    v_cvt_pk_bf16_f32 v26, v36, v37
    v_cvt_pk_bf16_f32 v27, v38, v39
    s_waitcnt lgkmcnt(4)
    v_mfma_f32_32x32x16_bf16 v[64:79], v[56:59], v[188:191], v[64:79]
    ds_read_b64_tr_b16 v[52:53], v7 offset:0
    ds_read_b64_tr_b16 v[54:55], v7 offset:512
    ds_write_b128 v14, v[24:27] offset:8448
    v_mul_f32 v40, v40, v19
    v_mul_f32 v41, v41, v19
    v_mul_f32 v42, v42, v19
    s_waitcnt lgkmcnt(5)
    v_mfma_f32_32x32x16_bf16 v[96:111], v[60:63], v[188:191], v[96:111]
    ds_read_b64_tr_b16 v[56:57], v5 offset:2048
    ds_read_b64_tr_b16 v[58:59], v5 offset:2560
    v_mul_f32 v43, v43, v19
    v_mul_f32 v44, v44, v19
    v_mul_f32 v45, v45, v19
    v_mul_f32 v46, v46, v19
    v_mul_f32 v47, v47, v19
    s_waitcnt lgkmcnt(5)
    v_mfma_f32_32x32x16_bf16 v[64:79], v[48:51], v[192:195], v[64:79]
    ds_read_b64_tr_b16 v[60:61], v7 offset:2048
    ds_read_b64_tr_b16 v[62:63], v7 offset:2560
    s_add_u32 m0, s70, 99328
    s_add_u32 s86, s74, 57344
    buffer_load_dwordx4 v10, s[36:39], s86 offen lds
    v_cvt_pk_bf16_f32 v24, v40, v41
    v_cvt_pk_bf16_f32 v25, v42, v43
    v_cvt_pk_bf16_f32 v26, v44, v45
    s_waitcnt lgkmcnt(5)
    v_mfma_f32_32x32x16_bf16 v[96:111], v[52:55], v[192:195], v[96:111]
    ds_read_b64_tr_b16 v[48:49], v5 offset:4096
    ds_read_b64_tr_b16 v[50:51], v5 offset:4608
    v_cvt_pk_bf16_f32 v27, v46, v47
    ds_write_b128 v14, v[24:27] offset:10560
    s_waitcnt lgkmcnt(5)
    v_mfma_f32_32x32x16_bf16 v[64:79], v[56:59], v[196:199], v[64:79]
    ds_read_b64_tr_b16 v[52:53], v7 offset:4096
    ds_read_b64_tr_b16 v[54:55], v7 offset:4608
    s_waitcnt lgkmcnt(2)
    s_and_b32 s89, s64, 1
    s_mul_i32 s88, s65, 8448
    v_and_b32 v16, 1, v0
    v_bfe_u32 v20, v0, 4, 1
    v_lshl_add_u32 v16, v16, 1, v20
    v_mfma_f32_32x32x16_bf16 v[96:111], v[60:63], v[196:199], v[96:111]
    ds_read_b64_tr_b16 v[56:57], v5 offset:6144
    ds_read_b64_tr_b16 v[58:59], v5 offset:6656
    v_mul_u32_u24 v16, 2112, v16
    v_bfe_u32 v21, v0, 2, 2
    v_lshrrev_b32 v22, 5, v0
    v_lshl_add_u32 v21, v22, 2, v21
    v_mfma_f32_32x32x16_bf16 v[64:79], v[48:51], v[200:203], v[64:79]
    ds_read_b64_tr_b16 v[60:61], v7 offset:6144
    ds_read_b64_tr_b16 v[62:63], v7 offset:6656
    v_lshl_add_u32 v16, v21, 4, v16
    v_bfe_u32 v21, v0, 1, 1
    s_waitcnt lgkmcnt(4)
    s_waitcnt vmcnt(6)
    s_barrier
    v_mfma_f32_32x32x16_bf16 v[96:111], v[52:55], v[200:203], v[96:111]
    ds_read_b64_tr_b16 v[48:49], v5 offset:16384
    ds_read_b64_tr_b16 v[50:51], v5 offset:16896
    s_add_u32 m0, s70, 114688
    s_add_u32 s86, s74, 458752
    buffer_load_dwordx4 v10, s[36:39], s86 offen lds
    v_lshlrev_b32 v21, 3, v21
    v_add3_u32 v16, v16, v21, s88
    v_cmp_eq_u32 vcc, s89, v20
    s_waitcnt lgkmcnt(4)
    v_mfma_f32_32x32x16_bf16 v[64:79], v[56:59], v[204:207], v[64:79]
    ds_read_b64_tr_b16 v[52:53], v7 offset:16384
    ds_read_b64_tr_b16 v[54:55], v7 offset:16896
    s_lshr_b32 s88, s65, 1
    s_lshl_b32 s88, s88, 13
    s_add_u32 s88, s88, 33792
    v_add_u32 v21, s88, v13
    v_mov_b32 v17, 58368
    v_cndmask_b32 v17, v17, v21, vcc
    s_waitcnt lgkmcnt(4)
    v_mfma_f32_32x32x16_bf16 v[96:111], v[60:63], v[204:207], v[96:111]
    ds_read_b64_tr_b16 v[56:57], v5 offset:18432
    ds_read_b64_tr_b16 v[58:59], v5 offset:18944
    v_mov_b32 v21, 1024
    v_cndmask_b32 v18, 0, v21, vcc
    v_and_b32 v21, 15, v0
    v_lshl_add_u32 v21, v22, 4, v21
    v_lshlrev_b32 v21, 4, v21
    s_waitcnt lgkmcnt(4)
    v_mfma_f32_32x32x16_bf16 v[64:79], v[48:51], v[208:211], v[64:79]
    ds_read_b64_tr_b16 v[60:61], v7 offset:18432
    ds_read_b64_tr_b16 v[62:63], v7 offset:18944
    s_add_u32 m0, s70, 115712
    s_add_u32 s86, s74, 516096
    buffer_load_dwordx4 v10, s[36:39], s86 offen lds
    s_lshl_b32 s88, s65, 9
    v_add_u32 v21, s88, v21
    s_lshl_b32 s88, s65, 5
    s_add_u32 s88, s88, 2048
    s_waitcnt lgkmcnt(4)
    v_mfma_f32_32x32x16_bf16 v[96:111], v[52:55], v[208:211], v[96:111]
    ds_read_b64_tr_b16 v[48:49], v5 offset:20480
    ds_read_b64_tr_b16 v[50:51], v5 offset:20992
    v_lshl_add_u32 v19, v22, 4, s88
    v_cndmask_b32 v19, v19, v21, vcc
    s_lshl_b32 s88, s66, 30
    v_add_u32 v19, s88, v19
    s_cmp_lg_u32 s66, 0
    s_cbranch_scc1 L_nokv_4
    ds_read_b64_tr_b16 v[24:25], v16 offset:0
    ds_read_b64_tr_b16 v[26:27], v16 offset:128
    ds_read_b128 v[28:31], v17
    v_add_u32 v17, v17, v18
    ds_read_b64_tr_b16 v[32:33], v16 offset:256
    ds_read_b64_tr_b16 v[34:35], v16 offset:384
    ds_read_b128 v[36:39], v17
    v_add_u32 v17, v17, v18
    ds_read_b64_tr_b16 v[40:41], v16 offset:512
    ds_read_b64_tr_b16 v[42:43], v16 offset:640
    ds_read_b128 v[44:47], v17
    v_add_u32 v17, v17, v18
    s_waitcnt lgkmcnt(6)
    v_mfma_f32_32x32x16_bf16 v[112:127], v[24:27], v[28:31], 0
    ds_read_b64_tr_b16 v[24:25], v16 offset:768
    ds_read_b64_tr_b16 v[26:27], v16 offset:896
    ds_read_b128 v[28:31], v17
    v_add_u32 v17, v17, v18
    s_waitcnt lgkmcnt(6)
    v_mfma_f32_32x32x16_bf16 v[112:127], v[32:35], v[36:39], v[112:127]
    ds_read_b64_tr_b16 v[32:33], v16 offset:1024
    ds_read_b64_tr_b16 v[34:35], v16 offset:1152
    ds_read_b128 v[36:39], v17
    v_add_u32 v17, v17, v18
    s_waitcnt lgkmcnt(6)
    v_mfma_f32_32x32x16_bf16 v[112:127], v[40:43], v[44:47], v[112:127]
    ds_read_b64_tr_b16 v[40:41], v16 offset:1280
    ds_read_b64_tr_b16 v[42:43], v16 offset:1408
    ds_read_b128 v[44:47], v17
    v_add_u32 v17, v17, v18
    s_waitcnt lgkmcnt(6)
    v_mfma_f32_32x32x16_bf16 v[112:127], v[24:27], v[28:31], v[112:127]
    ds_read_b64_tr_b16 v[24:25], v16 offset:1536
    ds_read_b64_tr_b16 v[26:27], v16 offset:1664
    ds_read_b128 v[28:31], v17
    v_add_u32 v17, v17, v18
    s_waitcnt lgkmcnt(6)
    v_mfma_f32_32x32x16_bf16 v[112:127], v[32:35], v[36:39], v[112:127]
    ds_read_b64_tr_b16 v[32:33], v16 offset:1792
    ds_read_b64_tr_b16 v[34:35], v16 offset:1920
    ds_read_b128 v[36:39], v17
    v_add_u32 v17, v17, v18
    s_waitcnt lgkmcnt(6)
    v_mfma_f32_32x32x16_bf16 v[112:127], v[40:43], v[44:47], v[112:127]
    s_waitcnt lgkmcnt(3)
    v_mfma_f32_32x32x16_bf16 v[112:127], v[24:27], v[28:31], v[112:127]
    s_waitcnt lgkmcnt(0)
    v_mfma_f32_32x32x16_bf16 v[112:127], v[32:35], v[36:39], v[112:127]
L_nokv_4:
    s_waitcnt lgkmcnt(4)
    v_mfma_f32_32x32x16_bf16 v[64:79], v[56:59], v[212:215], v[64:79]
    ds_read_b64_tr_b16 v[52:53], v7 offset:20480
    ds_read_b64_tr_b16 v[54:55], v7 offset:20992
    s_waitcnt lgkmcnt(4)
    v_mfma_f32_32x32x16_bf16 v[96:111], v[60:63], v[212:215], v[96:111]
    ds_read_b64_tr_b16 v[56:57], v5 offset:22528
    ds_read_b64_tr_b16 v[58:59], v5 offset:23040
    s_nop 3
    v_cvt_pk_bf16_f32 v24, v112, v113
    v_cvt_pk_bf16_f32 v25, v114, v115
    v_cvt_pk_bf16_f32 v26, v116, v117
    v_cvt_pk_bf16_f32 v27, v118, v119
    v_cvt_pk_bf16_f32 v28, v120, v121
    s_waitcnt lgkmcnt(4)
    v_mfma_f32_32x32x16_bf16 v[64:79], v[48:51], v[216:219], v[64:79]
    ds_read_b64_tr_b16 v[60:61], v7 offset:22528
    ds_read_b64_tr_b16 v[62:63], v7 offset:23040
    v_cvt_pk_bf16_f32 v29, v122, v123
    v_cvt_pk_bf16_f32 v30, v124, v125
    s_waitcnt lgkmcnt(4)
    s_waitcnt vmcnt(6)
    s_barrier
    v_mfma_f32_32x32x16_bf16 v[96:111], v[52:55], v[216:219], v[96:111]
    ds_read_b64_tr_b16 v[48:49], v4 offset:0
    ds_read_b64_tr_b16 v[50:51], v4 offset:512
    s_add_u32 m0, s70, 131072
    s_add_u32 s86, s74, 917504
    buffer_load_dwordx4 v10, s[36:39], s86 offen lds
    v_cvt_pk_bf16_f32 v31, v126, v127
    s_waitcnt lgkmcnt(4)
    v_mfma_f32_32x32x16_bf16 v[64:79], v[56:59], v[220:223], v[64:79]
    ds_read_b64_tr_b16 v[52:53], v6 offset:0
    ds_read_b64_tr_b16 v[54:55], v6 offset:512
    buffer_store_dwordx4 v[24:27], v19, s[40:43], s78 offen offset:0 sc1
    s_waitcnt lgkmcnt(4)
    v_mfma_f32_32x32x16_bf16 v[96:111], v[60:63], v[220:223], v[96:111]
    ds_read_b64_tr_b16 v[56:57], v4 offset:2048
    ds_read_b64_tr_b16 v[58:59], v4 offset:2560
    buffer_store_dwordx4 v[28:31], v19, s[40:43], s78 offen offset:2176 sc1
    s_waitcnt lgkmcnt(4)
    v_mfma_f32_32x32x16_bf16 v[64:79], v[48:51], v[224:227], v[64:79]
    ds_read_b64_tr_b16 v[60:61], v6 offset:2048
    ds_read_b64_tr_b16 v[62:63], v6 offset:2560
    s_add_u32 m0, s70, 132096
    s_add_u32 s86, s74, 974848
    buffer_load_dwordx4 v10, s[36:39], s86 offen lds
    v_and_b32 v11, 1, v0
    v_lshlrev_b32 v11, 7, v11
    s_waitcnt lgkmcnt(4)
    v_mfma_f32_32x32x16_bf16 v[96:111], v[52:55], v[224:227], v[96:111]
    ds_read_b64_tr_b16 v[48:49], v4 offset:4096
    ds_read_b64_tr_b16 v[50:51], v4 offset:4608
    v_bfe_u32 v20, v0, 1, 1
    v_lshl_or_b32 v11, v20, 9, v11
    v_lshrrev_b32 v20, 2, v0
    s_waitcnt lgkmcnt(4)
    v_mfma_f32_32x32x16_bf16 v[64:79], v[56:59], v[228:231], v[64:79]
    ds_read_b64_tr_b16 v[52:53], v6 offset:4096
    ds_read_b64_tr_b16 v[54:55], v6 offset:4608
    v_lshl_or_b32 v11, v20, 24, v11
    s_waitcnt lgkmcnt(4)
    v_mfma_f32_32x32x16_bf16 v[96:111], v[60:63], v[228:231], v[96:111]
    ds_read_b64_tr_b16 v[56:57], v4 offset:6144
    ds_read_b64_tr_b16 v[58:59], v4 offset:6656
    s_waitcnt lgkmcnt(4)
    v_mfma_f32_32x32x16_bf16 v[64:79], v[48:51], v[232:235], v[64:79]
    ds_read_b64_tr_b16 v[60:61], v6 offset:6144
    ds_read_b64_tr_b16 v[62:63], v6 offset:6656
    s_waitcnt lgkmcnt(4)
    s_waitcnt vmcnt(8)
    s_barrier
    v_mfma_f32_32x32x16_bf16 v[96:111], v[52:55], v[232:235], v[96:111]
    ds_read_b64_tr_b16 v[48:49], v4 offset:16384
    ds_read_b64_tr_b16 v[50:51], v4 offset:16896
    s_add_u32 m0, s70, 147456
    s_add_u32 s86, s74, 1376256
    buffer_load_dwordx4 v10, s[36:39], s86 offen lds
    s_waitcnt lgkmcnt(4)
    v_mfma_f32_32x32x16_bf16 v[64:79], v[56:59], v[236:239], v[64:79]
    ds_read_b64_tr_b16 v[52:53], v6 offset:16384
    ds_read_b64_tr_b16 v[54:55], v6 offset:16896
    s_waitcnt lgkmcnt(4)
    v_mfma_f32_32x32x16_bf16 v[96:111], v[60:63], v[236:239], v[96:111]
    ds_read_b64_tr_b16 v[56:57], v4 offset:18432
    ds_read_b64_tr_b16 v[58:59], v4 offset:18944
    s_waitcnt lgkmcnt(4)
    v_mfma_f32_32x32x16_bf16 v[64:79], v[48:51], v[240:243], v[64:79]
    ds_read_b64_tr_b16 v[60:61], v6 offset:18432
    ds_read_b64_tr_b16 v[62:63], v6 offset:18944
    s_add_u32 m0, s70, 148480
    s_add_u32 s86, s74, 1433600
    buffer_load_dwordx4 v10, s[36:39], s86 offen lds
    s_waitcnt lgkmcnt(4)
    v_mfma_f32_32x32x16_bf16 v[96:111], v[52:55], v[240:243], v[96:111]
    ds_read_b64_tr_b16 v[48:49], v4 offset:20480
    ds_read_b64_tr_b16 v[50:51], v4 offset:20992
    s_waitcnt lgkmcnt(4)
    v_mfma_f32_32x32x16_bf16 v[64:79], v[56:59], v[244:247], v[64:79]
    ds_read_b64_tr_b16 v[52:53], v6 offset:20480
    ds_read_b64_tr_b16 v[54:55], v6 offset:20992
    s_add_u32 m0, s70, 16384
    s_add_u32 s86, s8, 0
    buffer_load_dwordx4 v1, s[52:55], s86 offen lds
    s_waitcnt lgkmcnt(4)
    v_mfma_f32_32x32x16_bf16 v[96:111], v[60:63], v[244:247], v[96:111]
    ds_read_b64_tr_b16 v[56:57], v4 offset:22528
    ds_read_b64_tr_b16 v[58:59], v4 offset:23040
    s_waitcnt lgkmcnt(4)
    v_mfma_f32_32x32x16_bf16 v[64:79], v[48:51], v[248:251], v[64:79]
    ds_read_b64_tr_b16 v[60:61], v6 offset:22528
    ds_read_b64_tr_b16 v[62:63], v6 offset:23040
    s_waitcnt lgkmcnt(4)
    s_waitcnt vmcnt(9)
    s_barrier
    v_mfma_f32_32x32x16_bf16 v[96:111], v[52:55], v[248:251], v[96:111]
    ds_read_b64_tr_b16 v[48:49], v8 offset:32768
    ds_read_b64_tr_b16 v[50:51], v8 offset:33024
    s_add_u32 m0, s70, 17408
    s_add_u32 s86, s8, 8192
    buffer_load_dwordx4 v1, s[52:55], s86 offen lds
    s_waitcnt lgkmcnt(4)
    v_mfma_f32_32x32x16_bf16 v[64:79], v[56:59], v[252:255], v[64:79]
    ds_read_b64_tr_b16 v[52:53], v8 offset:33792
    ds_read_b64_tr_b16 v[54:55], v8 offset:34048
    v_bfe_u32 v21, v0, 2, 2
    v_lshrrev_b32 v22, 5, v0
    v_lshl_add_u32 v21, v22, 2, v21
    s_waitcnt lgkmcnt(4)
    v_mfma_f32_32x32x16_bf16 v[96:111], v[60:63], v[252:255], v[96:111]
    ds_read_b64_tr_b16 v[56:57], v8 offset:34816
    ds_read_b64_tr_b16 v[58:59], v8 offset:35072
    v_bfe_u32 v22, v0, 3, 2
    v_lshrrev_b32 v23, 1, v22
    v_and_b32 v22, 1, v22
    v_lshlrev_b32 v22, 6, v22
    s_waitcnt lgkmcnt(4)
    v_mfma_f32_32x32x16_bf16 v[80:95], v[48:51], v[128:131], 0
    ds_read_b64_tr_b16 v[60:61], v8 offset:35840
    ds_read_b64_tr_b16 v[62:63], v8 offset:36096
    s_add_u32 m0, s70, 32768
    s_add_u32 s86, s8, 32768
    buffer_load_dwordx4 v1, s[52:55], s86 offen lds
    v_lshl_or_b32 v22, v23, 5, v22
    v_and_b32 v23, 3, v0
    s_waitcnt lgkmcnt(4)
    v_mfma_f32_32x32x16_bf16 v[80:95], v[52:55], v[132:135], v[80:95]
    ds_read_b64_tr_b16 v[48:49], v8 offset:36864
    ds_read_b64_tr_b16 v[50:51], v8 offset:37120
    v_lshl_add_u32 v22, v23, 3, v22
    s_lshl_b32 s87, s16, 12
    s_add_u32 s87, s87, 16384
    v_lshl_add_u32 v4, v21, 7, v22
    v_add_u32 v4, s87, v4
    s_waitcnt lgkmcnt(4)
    v_mfma_f32_32x32x16_bf16 v[80:95], v[56:59], v[136:139], v[80:95]
    ds_read_b64_tr_b16 v[52:53], v8 offset:37888
    ds_read_b64_tr_b16 v[54:55], v8 offset:38144
    s_add_u32 m0, s70, 33792
    s_add_u32 s86, s8, 40960
    buffer_load_dwordx4 v1, s[52:55], s86 offen lds
    v_xor_b32 v4, 64, v4
    v_add_u32 v5, 0x10000, v4
    v_xor_b32 v2, 64, v4
    s_waitcnt lgkmcnt(4)
    v_mfma_f32_32x32x16_bf16 v[80:95], v[60:63], v[140:143], v[80:95]
    ds_read_b64_tr_b16 v[56:57], v8 offset:38912
    ds_read_b64_tr_b16 v[58:59], v8 offset:39168
    v_xor_b32 v3, 64, v5
    v_add_u32 v6, 0x20000, v4
    v_add_u32 v14, 0x20000, v2
    v_mul_f32 v16, s80, v64
    v_mul_f32 v17, s80, v65
    s_waitcnt lgkmcnt(4)
    v_mfma_f32_32x32x16_bf16 v[80:95], v[48:51], v[144:147], v[80:95]
    ds_read_b64_tr_b16 v[60:61], v8 offset:39936
    ds_read_b64_tr_b16 v[62:63], v8 offset:40192
    v_mul_f32 v18, s80, v66
    v_mul_f32 v19, s80, v67
    v_mul_f32 v20, s80, v68
    s_waitcnt lgkmcnt(4)
    s_waitcnt vmcnt(10)
    s_barrier
    v_lshlrev_b32 v37, 24, v0
    v_mov_b32 v36, 1
    s_waitcnt vmcnt(7)
    buffer_atomic_add v36, v37, s[40:43], s85 offen offset:0 sc1
    v_mfma_f32_32x32x16_bf16 v[80:95], v[52:55], v[148:151], v[80:95]
    ds_read_b64_tr_b16 v[48:49], v8 offset:49152
    ds_read_b64_tr_b16 v[50:51], v8 offset:49408
    s_add_u32 m0, s70, 49152
    s_add_u32 s86, s8, 131072
    buffer_load_dwordx4 v1, s[52:55], s86 offen lds
    v_mul_f32 v21, s80, v69
    v_mul_f32 v22, s80, v70
    v_mul_f32 v23, s80, v71
    s_waitcnt lgkmcnt(4)
    v_mfma_f32_32x32x16_bf16 v[80:95], v[56:59], v[152:155], v[80:95]
    ds_read_b64_tr_b16 v[52:53], v8 offset:50176
    ds_read_b64_tr_b16 v[54:55], v8 offset:50432
    v_exp_f32 v16, v16
    v_mul_f32 v72, v64, v72
    v_exp_f32 v17, v17
    v_mul_f32 v73, v65, v73
    s_waitcnt lgkmcnt(4)
    v_mfma_f32_32x32x16_bf16 v[80:95], v[60:63], v[156:159], v[80:95]
    ds_read_b64_tr_b16 v[56:57], v8 offset:51200
    ds_read_b64_tr_b16 v[58:59], v8 offset:51456
    v_exp_f32 v18, v18
    v_mul_f32 v74, v66, v74
    v_exp_f32 v19, v19
    v_mul_f32 v75, v67, v75
    s_waitcnt lgkmcnt(4)
    v_mfma_f32_32x32x16_bf16 v[80:95], v[48:51], v[160:163], v[80:95]
    ds_read_b64_tr_b16 v[60:61], v8 offset:52224
    ds_read_b64_tr_b16 v[62:63], v8 offset:52480
    s_add_u32 m0, s70, 50176
    s_add_u32 s86, s8, 139264
    buffer_load_dwordx4 v1, s[52:55], s86 offen lds
    v_exp_f32 v20, v20
    v_mul_f32 v76, v68, v76
    s_waitcnt lgkmcnt(4)
    v_mfma_f32_32x32x16_bf16 v[80:95], v[52:55], v[164:167], v[80:95]
    ds_read_b64_tr_b16 v[48:49], v8 offset:53248
    ds_read_b64_tr_b16 v[50:51], v8 offset:53504
    v_exp_f32 v21, v21
    v_mul_f32 v77, v69, v77
    v_exp_f32 v22, v22
    v_mul_f32 v78, v70, v78
    s_cmp_lg_u32 s64, 0
    s_cbranch_scc1 L_nos_5
    buffer_load_dword v120, v11, s[40:43], s84 offen offset:0 sc1
L_nos_5:
    s_waitcnt lgkmcnt(4)
    v_mfma_f32_32x32x16_bf16 v[80:95], v[56:59], v[168:171], v[80:95]
    ds_read_b64_tr_b16 v[52:53], v8 offset:54272
    ds_read_b64_tr_b16 v[54:55], v8 offset:54528
    s_add_u32 m0, s70, 65536
    s_add_u32 s86, s8, 163840
    buffer_load_dwordx4 v1, s[52:55], s86 offen lds
    v_exp_f32 v23, v23
    v_mul_f32 v79, v71, v79
    s_waitcnt lgkmcnt(4)
    v_mfma_f32_32x32x16_bf16 v[80:95], v[60:63], v[172:175], v[80:95]
    ds_read_b64_tr_b16 v[56:57], v8 offset:55296
    ds_read_b64_tr_b16 v[58:59], v8 offset:55552
    v_add_f32 v16, 1.0, v16
    v_add_f32 v17, 1.0, v17
    v_add_f32 v18, 1.0, v18
    v_add_f32 v19, 1.0, v19
    v_add_f32 v20, 1.0, v20
    v_add_f32 v21, 1.0, v21
    s_waitcnt lgkmcnt(4)
    v_mfma_f32_32x32x16_bf16 v[80:95], v[48:51], v[176:179], v[80:95]
    ds_read_b64_tr_b16 v[60:61], v8 offset:56320
    ds_read_b64_tr_b16 v[62:63], v8 offset:56576
    v_add_f32 v22, 1.0, v22
    v_add_f32 v23, 1.0, v23
    s_waitcnt lgkmcnt(4)
    s_waitcnt vmcnt(10)
    s_barrier
    v_mfma_f32_32x32x16_bf16 v[80:95], v[52:55], v[180:183], v[80:95]
    ds_read_b64_tr_b16 v[48:49], v9 offset:0
    ds_read_b64_tr_b16 v[50:51], v9 offset:256
    s_add_u32 m0, s70, 66560
    s_add_u32 s86, s8, 172032
    buffer_load_dwordx4 v1, s[52:55], s86 offen lds
    v_rcp_f32 v16, v16
    s_waitcnt lgkmcnt(4)
    v_mfma_f32_32x32x16_bf16 v[80:95], v[56:59], v[184:187], v[80:95]
    ds_read_b64_tr_b16 v[52:53], v9 offset:1024
    ds_read_b64_tr_b16 v[54:55], v9 offset:1280
    v_rcp_f32 v17, v17
    v_rcp_f32 v18, v18
    v_mul_f32 v72, v72, v16
    s_waitcnt lgkmcnt(4)
    v_mfma_f32_32x32x16_bf16 v[80:95], v[60:63], v[188:191], v[80:95]
    ds_read_b64_tr_b16 v[56:57], v9 offset:2048
    ds_read_b64_tr_b16 v[58:59], v9 offset:2304
    v_rcp_f32 v19, v19
    v_mul_f32 v73, v73, v17
    v_rcp_f32 v20, v20
    v_mul_f32 v74, v74, v18
    s_waitcnt lgkmcnt(4)
    v_mfma_f32_32x32x16_bf16 v[80:95], v[48:51], v[192:195], v[80:95]
    ds_read_b64_tr_b16 v[60:61], v9 offset:3072
    ds_read_b64_tr_b16 v[62:63], v9 offset:3328
    s_add_u32 m0, s70, 81920
    s_add_u32 s86, s9, 1048576
    buffer_load_dwordx4 v1, s[52:55], s86 offen lds
    v_rcp_f32 v21, v21
    v_mul_f32 v75, v75, v19
    s_waitcnt lgkmcnt(4)
    v_mfma_f32_32x32x16_bf16 v[80:95], v[52:55], v[196:199], v[80:95]
    ds_read_b64_tr_b16 v[48:49], v9 offset:4096
    ds_read_b64_tr_b16 v[50:51], v9 offset:4352
    v_rcp_f32 v22, v22
    v_mul_f32 v76, v76, v20
    v_rcp_f32 v23, v23
    v_mul_f32 v77, v77, v21
    s_waitcnt lgkmcnt(4)
    v_mfma_f32_32x32x16_bf16 v[80:95], v[56:59], v[200:203], v[80:95]
    ds_read_b64_tr_b16 v[52:53], v9 offset:5120
    ds_read_b64_tr_b16 v[54:55], v9 offset:5376
    s_add_u32 m0, s70, 82944
    s_add_u32 s86, s9, 1056768
    buffer_load_dwordx4 v1, s[52:55], s86 offen lds
    v_cvt_pk_bf16_f32 v64, v72, v73
    v_mul_f32 v78, v78, v22
    v_cvt_pk_bf16_f32 v65, v74, v75
    s_waitcnt lgkmcnt(4)
    v_mfma_f32_32x32x16_bf16 v[80:95], v[60:63], v[204:207], v[80:95]
    ds_read_b64_tr_b16 v[56:57], v9 offset:6144
    ds_read_b64_tr_b16 v[58:59], v9 offset:6400
    v_mul_f32 v79, v79, v23
    v_cvt_pk_bf16_f32 v66, v76, v77
    v_cvt_pk_bf16_f32 v67, v78, v79
    s_waitcnt lgkmcnt(4)
    v_mfma_f32_32x32x16_bf16 v[80:95], v[48:51], v[208:211], v[80:95]
    ds_read_b64_tr_b16 v[60:61], v9 offset:7168
    ds_read_b64_tr_b16 v[62:63], v9 offset:7424
    buffer_store_dwordx4 v[64:67], v13, s[40:43], s75 offen offset:0 sc1
    s_waitcnt lgkmcnt(4)
    s_cmp_lg_u32 s64, 0
    s_cbranch_scc1 L_ok_6
    s_waitcnt vmcnt(5)
    v_cmp_gt_u32 vcc, 8, v120
    s_nop 0
    s_mov_b32 s92, vcc_lo
    s_and_b32 s92, s92, 15
    s_cbranch_scc0 L_ok_6
    s_mov_b32 s91, 0
L_spin_7:
    buffer_load_dword v120, v11, s[40:43], s84 offen offset:0 sc1
    s_add_u32 s91, s91, 1
    s_cmp_ge_u32 s91, 0x80000
    s_cbranch_scc1 L_ok_6
    s_waitcnt vmcnt(0)

    v_cmp_gt_u32 vcc, 8, v120
    s_nop 0
    s_mov_b32 s92, vcc_lo
    s_and_b32 s92, s92, 15
    s_cbranch_scc1 L_spin_7
L_ok_6:
    s_waitcnt vmcnt(12)
    s_barrier
    v_mfma_f32_32x32x16_bf16 v[80:95], v[52:55], v[212:215], v[80:95]
    ds_read_b64_tr_b16 v[48:49], v9 offset:16384
    ds_read_b64_tr_b16 v[50:51], v9 offset:16640
    s_add_u32 s86, s11, 0
    buffer_load_dwordx4 v[144:147], v13, s[40:43], s86 offen offset:0 sc1
    v_mul_f32 v24, s80, v96
    v_mul_f32 v25, s80, v97
    v_mul_f32 v26, s80, v98
    s_waitcnt lgkmcnt(4)
    v_mfma_f32_32x32x16_bf16 v[80:95], v[56:59], v[216:219], v[80:95]
    ds_read_b64_tr_b16 v[52:53], v9 offset:17408
    ds_read_b64_tr_b16 v[54:55], v9 offset:17664
    v_mul_f32 v27, s80, v99
    v_mul_f32 v28, s80, v100
    v_mul_f32 v29, s80, v101
    v_mul_f32 v30, s80, v102
    v_mul_f32 v31, s80, v103
    s_waitcnt lgkmcnt(4)
    v_mfma_f32_32x32x16_bf16 v[80:95], v[60:63], v[220:223], v[80:95]
    ds_read_b64_tr_b16 v[56:57], v9 offset:18432
    ds_read_b64_tr_b16 v[58:59], v9 offset:18688
    v_exp_f32 v24, v24
    v_mul_f32 v104, v96, v104
    v_exp_f32 v25, v25
    v_mul_f32 v105, v97, v105
    s_waitcnt lgkmcnt(4)
    v_mfma_f32_32x32x16_bf16 v[80:95], v[48:51], v[224:227], v[80:95]
    ds_read_b64_tr_b16 v[60:61], v9 offset:19456
    ds_read_b64_tr_b16 v[62:63], v9 offset:19712
    s_add_u32 s86, s11, 0
    buffer_load_dwordx4 v[148:151], v13, s[40:43], s86 offen offset:1024 sc1
    v_exp_f32 v26, v26
    v_mul_f32 v106, v98, v106
    s_waitcnt lgkmcnt(4)
    v_mfma_f32_32x32x16_bf16 v[80:95], v[52:55], v[228:231], v[80:95]
    ds_read_b64_tr_b16 v[48:49], v9 offset:20480
    ds_read_b64_tr_b16 v[50:51], v9 offset:20736
    v_exp_f32 v27, v27
    v_mul_f32 v107, v99, v107
    v_exp_f32 v28, v28
    v_mul_f32 v108, v100, v108
    s_waitcnt lgkmcnt(4)
    v_mfma_f32_32x32x16_bf16 v[80:95], v[56:59], v[232:235], v[80:95]
    ds_read_b64_tr_b16 v[52:53], v9 offset:21504
    ds_read_b64_tr_b16 v[54:55], v9 offset:21760
    s_add_u32 s86, s11, 0
    buffer_load_dwordx4 v[152:155], v13, s[40:43], s86 offen offset:2048 sc1
    v_exp_f32 v29, v29
    v_mul_f32 v109, v101, v109
    s_waitcnt lgkmcnt(4)
    v_mfma_f32_32x32x16_bf16 v[80:95], v[60:63], v[236:239], v[80:95]
    ds_read_b64_tr_b16 v[56:57], v9 offset:22528
    ds_read_b64_tr_b16 v[58:59], v9 offset:22784
    v_exp_f32 v30, v30
    v_mul_f32 v110, v102, v110
    v_exp_f32 v31, v31
    v_mul_f32 v111, v103, v111
    s_waitcnt lgkmcnt(4)
    v_mfma_f32_32x32x16_bf16 v[80:95], v[48:51], v[240:243], v[80:95]
    ds_read_b64_tr_b16 v[60:61], v9 offset:23552
    ds_read_b64_tr_b16 v[62:63], v9 offset:23808
    v_add_f32 v24, 1.0, v24
    v_add_f32 v25, 1.0, v25
    v_add_f32 v26, 1.0, v26
    v_add_f32 v27, 1.0, v27
    v_add_f32 v28, 1.0, v28
    v_add_f32 v29, 1.0, v29
    s_waitcnt lgkmcnt(4)
    v_mfma_f32_32x32x16_bf16 v[80:95], v[52:55], v[244:247], v[80:95]
    v_add_f32 v30, 1.0, v30
    v_add_f32 v31, 1.0, v31
    v_rcp_f32 v24, v24
    v_rcp_f32 v25, v25
    s_waitcnt lgkmcnt(2)
    v_mfma_f32_32x32x16_bf16 v[80:95], v[56:59], v[248:251], v[80:95]
    v_rcp_f32 v26, v26
    v_mul_f32 v104, v104, v24
    v_rcp_f32 v27, v27
    v_mul_f32 v105, v105, v25
    s_waitcnt lgkmcnt(0)
    v_mfma_f32_32x32x16_bf16 v[80:95], v[60:63], v[252:255], v[80:95]
    v_rcp_f32 v28, v28
    v_mul_f32 v106, v106, v26
    v_rcp_f32 v29, v29
    v_mul_f32 v107, v107, v27
    v_rcp_f32 v30, v30
    v_mul_f32 v108, v108, v28
    v_rcp_f32 v31, v31
    v_mul_f32 v109, v109, v29
    v_cvt_pk_bf16_f32 v96, v104, v105
    v_mul_f32 v110, v110, v30
    v_cvt_pk_bf16_f32 v97, v106, v107
    v_mul_f32 v111, v111, v31
    v_cvt_pk_bf16_f32 v98, v108, v109
    v_cvt_pk_bf16_f32 v99, v110, v111
    buffer_store_dwordx4 v[96:99], v13, s[40:43], s75 offen offset:1024 sc1
    v_mul_f32 v16, s80, v80
    v_mul_f32 v17, s80, v81
    v_mul_f32 v18, s80, v82
    v_mul_f32 v19, s80, v83
    v_mul_f32 v20, s80, v84
    v_mul_f32 v21, s80, v85
    v_mul_f32 v22, s80, v86
    v_mul_f32 v23, s80, v87
    v_exp_f32 v16, v16
    v_mul_f32 v88, v80, v88
    v_exp_f32 v17, v17
    v_mul_f32 v89, v81, v89
    v_exp_f32 v18, v18
    v_mul_f32 v90, v82, v90
    v_exp_f32 v19, v19
    v_mul_f32 v91, v83, v91
    v_exp_f32 v20, v20
    v_mul_f32 v92, v84, v92
    v_exp_f32 v21, v21
    v_mul_f32 v93, v85, v93
    v_exp_f32 v22, v22
    v_mul_f32 v94, v86, v94
    v_exp_f32 v23, v23
    v_mul_f32 v95, v87, v95
    v_add_f32 v16, 1.0, v16
    v_add_f32 v17, 1.0, v17
    v_add_f32 v18, 1.0, v18
    v_add_f32 v19, 1.0, v19
    v_add_f32 v20, 1.0, v20
    v_add_f32 v21, 1.0, v21
    v_add_f32 v22, 1.0, v22
    v_add_f32 v23, 1.0, v23
    v_rcp_f32 v16, v16
    v_rcp_f32 v17, v17
    v_rcp_f32 v18, v18
    v_mul_f32 v88, v88, v16
    v_rcp_f32 v19, v19
    v_mul_f32 v89, v89, v17
    v_rcp_f32 v20, v20
    v_mul_f32 v90, v90, v18
    v_rcp_f32 v21, v21
    v_mul_f32 v91, v91, v19
    v_rcp_f32 v22, v22
    v_mul_f32 v92, v92, v20
    v_rcp_f32 v23, v23
    v_mul_f32 v93, v93, v21
    v_cvt_pk_bf16_f32 v80, v88, v89
    v_mul_f32 v94, v94, v22
    v_cvt_pk_bf16_f32 v81, v90, v91
    v_mul_f32 v95, v95, v23
    v_cvt_pk_bf16_f32 v82, v92, v93
    v_cvt_pk_bf16_f32 v83, v94, v95
    buffer_store_dwordx4 v[80:83], v13, s[40:43], s76 offen offset:0 sc1
    s_add_u32 s86, s11, 0
    buffer_load_dwordx4 v[156:159], v13, s[40:43], s86 offen offset:3072 sc1
    s_add_u32 s86, s11, 8192
    buffer_load_dwordx4 v[160:163], v13, s[40:43], s86 offen offset:0 sc1
    s_add_u32 s86, s11, 8192
    buffer_load_dwordx4 v[164:167], v13, s[40:43], s86 offen offset:1024 sc1
    s_add_u32 s86, s11, 8192
    buffer_load_dwordx4 v[168:171], v13, s[40:43], s86 offen offset:2048 sc1
    v_lshlrev_b32 v33, 24, v0
    v_mov_b32 v32, 1
    s_waitcnt vmcnt(5)
    buffer_atomic_add v32, v33, s[40:43], s83 offen offset:4 sc1
    s_barrier
    ds_read_b64_tr_b16 v[48:49], v2 offset:0
    ds_read_b64_tr_b16 v[50:51], v2 offset:1024
    ds_read_b64_tr_b16 v[52:53], v4 offset:0
    ds_read_b64_tr_b16 v[54:55], v4 offset:1024
    ds_read_b64_tr_b16 v[56:57], v2 offset:2048
    ds_read_b64_tr_b16 v[58:59], v2 offset:3072
    s_waitcnt lgkmcnt(4)
    v_mfma_f32_32x32x16_bf16 v[96:111], v[48:51], v[144:147], 0
    ds_read_b64_tr_b16 v[60:61], v4 offset:2048
    ds_read_b64_tr_b16 v[62:63], v4 offset:3072
    s_add_u32 s86, s11, 8192
    buffer_load_dwordx4 v[172:175], v13, s[40:43], s86 offen offset:3072 sc1
    s_waitcnt lgkmcnt(4)
    v_mfma_f32_32x32x16_bf16 v[112:127], v[52:55], v[144:147], 0
    ds_read_b64_tr_b16 v[48:49], v2 offset:16384
    ds_read_b64_tr_b16 v[50:51], v2 offset:17408
    s_add_u32 m0, s70, 98304
    s_add_u32 s86, s9, 1081344
    buffer_load_dwordx4 v1, s[52:55], s86 offen lds
    s_waitcnt lgkmcnt(4)
    v_mfma_f32_32x32x16_bf16 v[96:111], v[56:59], v[148:151], v[96:111]
    ds_read_b64_tr_b16 v[52:53], v4 offset:16384
    ds_read_b64_tr_b16 v[54:55], v4 offset:17408
    s_add_u32 m0, s70, 99328
    s_add_u32 s86, s9, 1089536
    buffer_load_dwordx4 v1, s[52:55], s86 offen lds
    s_waitcnt lgkmcnt(4)
    v_mfma_f32_32x32x16_bf16 v[112:127], v[60:63], v[148:151], v[112:127]
    ds_read_b64_tr_b16 v[56:57], v2 offset:18432
    ds_read_b64_tr_b16 v[58:59], v2 offset:19456
    s_add_u32 m0, s70, 114688
    s_add_u32 s86, s9, 1114112
    buffer_load_dwordx4 v1, s[52:55], s86 offen lds
    v_lshlrev_b32 v33, 24, v0
    v_mov_b32 v32, 1
    s_waitcnt vmcnt(9)
    buffer_atomic_add v32, v33, s[40:43], s83 offen offset:8 sc1
    s_waitcnt lgkmcnt(4)
    v_mfma_f32_32x32x16_bf16 v[96:111], v[48:51], v[152:155], v[96:111]
    ds_read_b64_tr_b16 v[60:61], v4 offset:18432
    ds_read_b64_tr_b16 v[62:63], v4 offset:19456
    s_add_u32 m0, s70, 115712
    s_add_u32 s86, s9, 1122304
    buffer_load_dwordx4 v1, s[52:55], s86 offen lds
    s_waitcnt lgkmcnt(4)
    s_barrier
    v_mfma_f32_32x32x16_bf16 v[112:127], v[52:55], v[152:155], v[112:127]
    ds_read_b64_tr_b16 v[48:49], v2 offset:32768
    ds_read_b64_tr_b16 v[50:51], v2 offset:33792
    s_add_u32 m0, s70, 131072
    s_add_u32 s86, s9, 1146880
    buffer_load_dwordx4 v1, s[52:55], s86 offen lds
    s_waitcnt vmcnt(11) lgkmcnt(4)
    v_mfma_f32_32x32x16_bf16 v[96:111], v[56:59], v[156:159], v[96:111]
    ds_read_b64_tr_b16 v[52:53], v4 offset:32768
    ds_read_b64_tr_b16 v[54:55], v4 offset:33792
    s_add_u32 m0, s70, 132096
    s_add_u32 s86, s9, 1155072
    buffer_load_dwordx4 v1, s[52:55], s86 offen lds
    s_waitcnt lgkmcnt(4)
    v_mfma_f32_32x32x16_bf16 v[112:127], v[60:63], v[156:159], v[112:127]
    ds_read_b64_tr_b16 v[56:57], v2 offset:34816
    ds_read_b64_tr_b16 v[58:59], v2 offset:35840
    s_add_u32 m0, s70, 147456
    s_add_u32 s86, s8, 65536
    buffer_load_dwordx4 v1, s[52:55], s86 offen lds
    s_waitcnt vmcnt(12) lgkmcnt(4)
    v_mfma_f32_32x32x16_bf16 v[96:111], v[48:51], v[160:163], v[96:111]
    ds_read_b64_tr_b16 v[60:61], v4 offset:34816
    ds_read_b64_tr_b16 v[62:63], v4 offset:35840
    s_add_u32 m0, s70, 148480
    s_add_u32 s86, s8, 73728
    buffer_load_dwordx4 v1, s[52:55], s86 offen lds
    s_waitcnt lgkmcnt(4)
    v_mfma_f32_32x32x16_bf16 v[112:127], v[52:55], v[160:163], v[112:127]
    ds_read_b64_tr_b16 v[48:49], v2 offset:49152
    ds_read_b64_tr_b16 v[50:51], v2 offset:50176
    s_waitcnt vmcnt(12) lgkmcnt(4)
    v_mfma_f32_32x32x16_bf16 v[96:111], v[56:59], v[164:167], v[96:111]
    ds_read_b64_tr_b16 v[52:53], v4 offset:49152
    ds_read_b64_tr_b16 v[54:55], v4 offset:50176
    s_waitcnt lgkmcnt(4)
    v_mfma_f32_32x32x16_bf16 v[112:127], v[60:63], v[164:167], v[112:127]
    ds_read_b64_tr_b16 v[56:57], v2 offset:51200
    ds_read_b64_tr_b16 v[58:59], v2 offset:52224
    s_waitcnt vmcnt(11) lgkmcnt(4)
    v_mfma_f32_32x32x16_bf16 v[96:111], v[48:51], v[168:171], v[96:111]
    ds_read_b64_tr_b16 v[60:61], v4 offset:51200
    ds_read_b64_tr_b16 v[62:63], v4 offset:52224
    s_waitcnt lgkmcnt(4)
    v_mfma_f32_32x32x16_bf16 v[112:127], v[52:55], v[168:171], v[112:127]
    s_waitcnt vmcnt(9) lgkmcnt(2)
    v_mfma_f32_32x32x16_bf16 v[96:111], v[56:59], v[172:175], v[96:111]
    s_waitcnt lgkmcnt(0)
    v_mfma_f32_32x32x16_bf16 v[112:127], v[60:63], v[172:175], v[112:127]
    s_barrier
    s_add_u32 m0, s70, 16384
    s_add_u32 s86, s8, 98304
    buffer_load_dwordx4 v1, s[52:55], s86 offen lds
    s_add_u32 m0, s70, 17408
    s_add_u32 s86, s8, 106496
    buffer_load_dwordx4 v1, s[52:55], s86 offen lds
    s_add_u32 m0, s70, 32768
    s_add_u32 s86, s8, 196608
    buffer_load_dwordx4 v1, s[52:55], s86 offen lds
    s_add_u32 m0, s70, 33792
    s_add_u32 s86, s8, 204800
    buffer_load_dwordx4 v1, s[52:55], s86 offen lds
    s_add_u32 m0, s70, 49152
    s_add_u32 s86, s8, 229376
    buffer_load_dwordx4 v1, s[52:55], s86 offen lds
    s_add_u32 m0, s70, 50176
    s_add_u32 s86, s8, 237568
    buffer_load_dwordx4 v1, s[52:55], s86 offen lds
    s_add_u32 m0, s70, 65536
    s_add_u32 s86, s10, 1572864
    buffer_load_dwordx4 v1, s[52:55], s86 offen lds
    s_add_u32 m0, s70, 66560
    s_add_u32 s86, s10, 1581056
    buffer_load_dwordx4 v1, s[52:55], s86 offen lds
    s_waitcnt vmcnt(8)
    s_barrier
    ds_read_b64_tr_b16 v[16:17], v3 offset:0
    ds_read_b64_tr_b16 v[18:19], v3 offset:1024
    ds_read_b64_tr_b16 v[20:21], v5 offset:0
    ds_read_b64_tr_b16 v[22:23], v5 offset:1024
    ds_read_b64_tr_b16 v[24:25], v3 offset:2048
    ds_read_b64_tr_b16 v[26:27], v3 offset:3072
    ds_read_b64_tr_b16 v[28:29], v5 offset:2048
    ds_read_b64_tr_b16 v[30:31], v5 offset:3072
    ds_read_b64_tr_b16 v[32:33], v3 offset:16384
    ds_read_b64_tr_b16 v[34:35], v3 offset:17408
    ds_read_b64_tr_b16 v[36:37], v5 offset:16384
    ds_read_b64_tr_b16 v[38:39], v5 offset:17408
    ds_read_b64_tr_b16 v[40:41], v3 offset:18432
    ds_read_b64_tr_b16 v[42:43], v3 offset:19456
    ds_read_b64_tr_b16 v[44:45], v5 offset:18432
    ds_read_b64_tr_b16 v[46:47], v5 offset:19456
    ds_read_b64_tr_b16 v[64:65], v3 offset:32768
    ds_read_b64_tr_b16 v[66:67], v3 offset:33792
    ds_read_b64_tr_b16 v[68:69], v5 offset:32768
    ds_read_b64_tr_b16 v[70:71], v5 offset:33792
    ds_read_b64_tr_b16 v[72:73], v3 offset:34816
    ds_read_b64_tr_b16 v[74:75], v3 offset:35840
    ds_read_b64_tr_b16 v[76:77], v5 offset:34816
    ds_read_b64_tr_b16 v[78:79], v5 offset:35840
    ds_read_b64_tr_b16 v[80:81], v3 offset:49152
    ds_read_b64_tr_b16 v[82:83], v3 offset:50176
    ds_read_b64_tr_b16 v[84:85], v5 offset:49152
    ds_read_b64_tr_b16 v[86:87], v5 offset:50176
    ds_read_b64_tr_b16 v[88:89], v3 offset:51200
    ds_read_b64_tr_b16 v[90:91], v3 offset:52224
    ds_read_b64_tr_b16 v[92:93], v5 offset:51200
    ds_read_b64_tr_b16 v[94:95], v5 offset:52224
    ds_read_b64_tr_b16 v[128:129], v14 offset:0
    ds_read_b64_tr_b16 v[130:131], v14 offset:1024
    ds_read_b64_tr_b16 v[132:133], v6 offset:0
    ds_read_b64_tr_b16 v[134:135], v6 offset:1024
    ds_read_b64_tr_b16 v[136:137], v14 offset:2048
    ds_read_b64_tr_b16 v[138:139], v14 offset:3072
    ds_read_b64_tr_b16 v[140:141], v6 offset:2048
    ds_read_b64_tr_b16 v[142:143], v6 offset:3072
    s_waitcnt lgkmcnt(0)
    s_barrier
    s_add_u32 m0, s70, 81920
    s_add_u32 s86, s10, 1605632
    buffer_load_dwordx4 v1, s[52:55], s86 offen lds
    s_add_u32 m0, s70, 82944
    s_add_u32 s86, s10, 1613824
    buffer_load_dwordx4 v1, s[52:55], s86 offen lds
    s_add_u32 m0, s70, 98304
    s_add_u32 s86, s9, 0
    buffer_load_dwordx4 v1, s[56:59], s86 offen lds
    s_add_u32 m0, s70, 99328
    s_add_u32 s86, s9, 8192
    buffer_load_dwordx4 v1, s[56:59], s86 offen lds
    s_add_u32 m0, s70, 114688
    s_add_u32 s86, s9, 32768
    buffer_load_dwordx4 v1, s[56:59], s86 offen lds
    s_add_u32 m0, s70, 115712
    s_add_u32 s86, s9, 40960
    buffer_load_dwordx4 v1, s[56:59], s86 offen lds
    s_add_u32 m0, s70, 131072
    s_add_u32 s86, s9, 65536
    buffer_load_dwordx4 v1, s[56:59], s86 offen lds
    s_add_u32 m0, s70, 132096
    s_add_u32 s86, s9, 73728
    buffer_load_dwordx4 v1, s[56:59], s86 offen lds
    s_add_u32 m0, s70, 147456
    s_add_u32 s86, s9, 98304
    buffer_load_dwordx4 v1, s[56:59], s86 offen lds
    s_add_u32 m0, s70, 148480
    s_add_u32 s86, s9, 106496
    buffer_load_dwordx4 v1, s[56:59], s86 offen lds
    s_cmp_lg_u32 s64, 0
    s_cbranch_scc1 L_nos_8
    buffer_load_dwordx2 v[174:175], v11, s[40:43], s84 offen offset:4 sc1
L_nos_8:
    s_cmp_lg_u32 s64, 0
    s_cbranch_scc1 L_ok_9
    s_waitcnt vmcnt(0)
    v_cmp_gt_u32 vcc, 8, v174
    s_nop 0
    s_mov_b32 s92, vcc_lo
    v_cmp_gt_u32 vcc, 16, v175
    s_nop 0
    s_or_b32 s92, s92, vcc_lo
    s_and_b32 s92, s92, 15
    s_cbranch_scc0 L_ok_9
    s_mov_b32 s91, 0
L_spin_10:
    buffer_load_dwordx2 v[174:175], v11, s[40:43], s84 offen offset:4 sc1
    s_add_u32 s91, s91, 1
    s_cmp_ge_u32 s91, 0x80000
    s_cbranch_scc1 L_ok_9
    s_waitcnt vmcnt(0)

    v_cmp_gt_u32 vcc, 8, v174
    s_nop 0
    s_mov_b32 s92, vcc_lo
    v_cmp_gt_u32 vcc, 16, v175
    s_nop 0
    s_or_b32 s92, s92, vcc_lo
    s_and_b32 s92, s92, 15
    s_cbranch_scc1 L_spin_10
L_ok_9:
    s_waitcnt vmcnt(14)
    s_barrier
    s_add_u32 s86, s12, 65536
    buffer_load_dwordx4 v[176:179], v13, s[40:43], s86 offen offset:0 sc1
    s_add_u32 s86, s12, 65536
    buffer_load_dwordx4 v[180:183], v13, s[40:43], s86 offen offset:1024 sc1
    s_add_u32 s86, s12, 65536
    buffer_load_dwordx4 v[184:187], v13, s[40:43], s86 offen offset:2048 sc1
    s_add_u32 s86, s12, 65536
    buffer_load_dwordx4 v[188:191], v13, s[40:43], s86 offen offset:3072 sc1
    s_add_u32 s86, s12, 69632
    buffer_load_dwordx4 v[192:195], v13, s[40:43], s86 offen offset:0 sc1
    s_add_u32 s86, s12, 69632
    buffer_load_dwordx4 v[196:199], v13, s[40:43], s86 offen offset:1024 sc1
    s_add_u32 s86, s12, 69632
    buffer_load_dwordx4 v[200:203], v13, s[40:43], s86 offen offset:2048 sc1
    s_add_u32 s86, s12, 69632
    buffer_load_dwordx4 v[204:207], v13, s[40:43], s86 offen offset:3072 sc1
    s_waitcnt vmcnt(7)
    v_mfma_f32_32x32x16_bf16 v[96:111], v[16:19], v[176:179], v[96:111]
    v_mfma_f32_32x32x16_bf16 v[112:127], v[20:23], v[176:179], v[112:127]
    s_add_u32 s86, s11, 4096
    buffer_load_dwordx4 v[208:211], v13, s[40:43], s86 offen offset:0 sc1
    s_waitcnt vmcnt(7)
    v_mfma_f32_32x32x16_bf16 v[96:111], v[24:27], v[180:183], v[96:111]
    v_mfma_f32_32x32x16_bf16 v[112:127], v[28:31], v[180:183], v[112:127]
    s_add_u32 s86, s11, 4096
    buffer_load_dwordx4 v[212:215], v13, s[40:43], s86 offen offset:1024 sc1
    s_waitcnt vmcnt(7)
    v_mfma_f32_32x32x16_bf16 v[96:111], v[32:35], v[184:187], v[96:111]
    v_mfma_f32_32x32x16_bf16 v[112:127], v[36:39], v[184:187], v[112:127]
    s_add_u32 s86, s11, 4096
    buffer_load_dwordx4 v[216:219], v13, s[40:43], s86 offen offset:2048 sc1
    s_waitcnt vmcnt(7)
    v_mfma_f32_32x32x16_bf16 v[96:111], v[40:43], v[188:191], v[96:111]
    v_mfma_f32_32x32x16_bf16 v[112:127], v[44:47], v[188:191], v[112:127]
    s_add_u32 s86, s11, 4096
    buffer_load_dwordx4 v[220:223], v13, s[40:43], s86 offen offset:3072 sc1
    s_waitcnt vmcnt(7)
    v_mfma_f32_32x32x16_bf16 v[96:111], v[64:67], v[192:195], v[96:111]
    v_mfma_f32_32x32x16_bf16 v[112:127], v[68:71], v[192:195], v[112:127]
    s_add_u32 s86, s11, 12288
    buffer_load_dwordx4 v[224:227], v13, s[40:43], s86 offen offset:0 sc1
    s_waitcnt vmcnt(7)
    v_mfma_f32_32x32x16_bf16 v[96:111], v[72:75], v[196:199], v[96:111]
    v_mfma_f32_32x32x16_bf16 v[112:127], v[76:79], v[196:199], v[112:127]
    s_add_u32 s86, s11, 12288
    buffer_load_dwordx4 v[228:231], v13, s[40:43], s86 offen offset:1024 sc1
    s_waitcnt vmcnt(7)
    v_mfma_f32_32x32x16_bf16 v[96:111], v[80:83], v[200:203], v[96:111]
    v_mfma_f32_32x32x16_bf16 v[112:127], v[84:87], v[200:203], v[112:127]
    s_add_u32 s86, s11, 12288
    buffer_load_dwordx4 v[232:235], v13, s[40:43], s86 offen offset:2048 sc1
    s_waitcnt vmcnt(7)
    v_mfma_f32_32x32x16_bf16 v[96:111], v[88:91], v[204:207], v[96:111]
    v_mfma_f32_32x32x16_bf16 v[112:127], v[92:95], v[204:207], v[112:127]
    s_add_u32 s86, s11, 12288
    buffer_load_dwordx4 v[236:239], v13, s[40:43], s86 offen offset:3072 sc1
    s_waitcnt vmcnt(7)
    v_mfma_f32_32x32x16_bf16 v[96:111], v[128:131], v[208:211], v[96:111]
    v_mfma_f32_32x32x16_bf16 v[112:127], v[132:135], v[208:211], v[112:127]
    ds_read_b64_tr_b16 v[48:49], v2 offset:0
    ds_read_b64_tr_b16 v[50:51], v2 offset:1024
    s_add_u32 s86, s13, 98304
    buffer_load_dwordx4 v[240:243], v13, s[40:43], s86 offen offset:0 sc1
    s_waitcnt vmcnt(7)
    v_mfma_f32_32x32x16_bf16 v[96:111], v[136:139], v[212:215], v[96:111]
    ds_read_b64_tr_b16 v[52:53], v4 offset:0
    ds_read_b64_tr_b16 v[54:55], v4 offset:1024
    v_mfma_f32_32x32x16_bf16 v[112:127], v[140:143], v[212:215], v[112:127]
    ds_read_b64_tr_b16 v[56:57], v2 offset:2048
    ds_read_b64_tr_b16 v[58:59], v2 offset:3072
    s_add_u32 s86, s13, 98304
    buffer_load_dwordx4 v[244:247], v13, s[40:43], s86 offen offset:1024 sc1
    s_cmp_lg_u32 s64, 0
    s_cbranch_scc1 L_nos_11
    buffer_load_dword v174, v11, s[40:43], s84 offen offset:12 sc1
L_nos_11:
    s_waitcnt vmcnt(7) lgkmcnt(4)
    v_mfma_f32_32x32x16_bf16 v[96:111], v[48:51], v[216:219], v[96:111]
    ds_read_b64_tr_b16 v[60:61], v4 offset:2048
    ds_read_b64_tr_b16 v[62:63], v4 offset:3072
    s_waitcnt lgkmcnt(4)
    s_barrier
    v_mfma_f32_32x32x16_bf16 v[112:127], v[52:55], v[216:219], v[112:127]
    ds_read_b64_tr_b16 v[48:49], v2 offset:16384
    ds_read_b64_tr_b16 v[50:51], v2 offset:17408
    s_add_u32 s86, s13, 98304
    buffer_load_dwordx4 v[248:251], v13, s[40:43], s86 offen offset:2048 sc1
    s_waitcnt vmcnt(7) lgkmcnt(4)
    v_mfma_f32_32x32x16_bf16 v[96:111], v[56:59], v[220:223], v[96:111]
    ds_read_b64_tr_b16 v[52:53], v4 offset:16384
    ds_read_b64_tr_b16 v[54:55], v4 offset:17408
    s_waitcnt lgkmcnt(4)
    v_mfma_f32_32x32x16_bf16 v[112:127], v[60:63], v[220:223], v[112:127]
    ds_read_b64_tr_b16 v[56:57], v2 offset:18432
    ds_read_b64_tr_b16 v[58:59], v2 offset:19456
    s_add_u32 s86, s13, 98304
    buffer_load_dwordx4 v[252:255], v13, s[40:43], s86 offen offset:3072 sc1
    s_cmp_lg_u32 s64, 0
    s_cbranch_scc1 L_ok_12
    s_waitcnt vmcnt(2)
    v_cmp_gt_u32 vcc, 8, v174
    s_nop 0
    s_mov_b32 s92, vcc_lo
    s_and_b32 s92, s92, 15
    s_cbranch_scc0 L_ok_12
    s_mov_b32 s91, 0
L_spin_13:
    buffer_load_dword v174, v11, s[40:43], s84 offen offset:12 sc1
    s_add_u32 s91, s91, 1
    s_cmp_ge_u32 s91, 0x80000
    s_cbranch_scc1 L_ok_12
    s_waitcnt vmcnt(0)

    v_cmp_gt_u32 vcc, 8, v174
    s_nop 0
    s_mov_b32 s92, vcc_lo
    s_and_b32 s92, s92, 15
    s_cbranch_scc1 L_spin_13
L_ok_12:
    s_barrier
    s_waitcnt vmcnt(7) lgkmcnt(4)
    v_mfma_f32_32x32x16_bf16 v[96:111], v[48:51], v[224:227], v[96:111]
    ds_read_b64_tr_b16 v[60:61], v4 offset:18432
    ds_read_b64_tr_b16 v[62:63], v4 offset:19456
    s_waitcnt lgkmcnt(4)
    v_mfma_f32_32x32x16_bf16 v[112:127], v[52:55], v[224:227], v[112:127]
    ds_read_b64_tr_b16 v[48:49], v2 offset:32768
    ds_read_b64_tr_b16 v[50:51], v2 offset:33792
    s_add_u32 s86, s12, 114688
    buffer_load_dwordx4 v[144:147], v13, s[40:43], s86 offen offset:0 sc1
    s_waitcnt vmcnt(7) lgkmcnt(4)
    v_mfma_f32_32x32x16_bf16 v[96:111], v[56:59], v[228:231], v[96:111]
    ds_read_b64_tr_b16 v[52:53], v4 offset:32768
    ds_read_b64_tr_b16 v[54:55], v4 offset:33792
    s_waitcnt lgkmcnt(4)
    v_mfma_f32_32x32x16_bf16 v[112:127], v[60:63], v[228:231], v[112:127]
    ds_read_b64_tr_b16 v[56:57], v2 offset:34816
    ds_read_b64_tr_b16 v[58:59], v2 offset:35840
    s_add_u32 s86, s12, 114688
    buffer_load_dwordx4 v[148:151], v13, s[40:43], s86 offen offset:1024 sc1
    s_waitcnt vmcnt(7) lgkmcnt(4)
    v_mfma_f32_32x32x16_bf16 v[96:111], v[48:51], v[232:235], v[96:111]
    ds_read_b64_tr_b16 v[60:61], v4 offset:34816
    ds_read_b64_tr_b16 v[62:63], v4 offset:35840
    s_waitcnt lgkmcnt(4)
    s_barrier
    v_mfma_f32_32x32x16_bf16 v[112:127], v[52:55], v[232:235], v[112:127]
    ds_read_b64_tr_b16 v[48:49], v2 offset:49152
    ds_read_b64_tr_b16 v[50:51], v2 offset:50176
    s_add_u32 s86, s12, 114688
    buffer_load_dwordx4 v[152:155], v13, s[40:43], s86 offen offset:2048 sc1
    s_waitcnt vmcnt(7) lgkmcnt(4)
    v_mfma_f32_32x32x16_bf16 v[96:111], v[56:59], v[236:239], v[96:111]
    ds_read_b64_tr_b16 v[52:53], v4 offset:49152
    ds_read_b64_tr_b16 v[54:55], v4 offset:50176
    s_waitcnt lgkmcnt(4)
    v_mfma_f32_32x32x16_bf16 v[112:127], v[60:63], v[236:239], v[112:127]
    ds_read_b64_tr_b16 v[56:57], v2 offset:51200
    ds_read_b64_tr_b16 v[58:59], v2 offset:52224
    s_add_u32 s86, s12, 114688
    buffer_load_dwordx4 v[156:159], v13, s[40:43], s86 offen offset:3072 sc1
    s_waitcnt vmcnt(7) lgkmcnt(4)
    v_mfma_f32_32x32x16_bf16 v[96:111], v[48:51], v[240:243], v[96:111]
    ds_read_b64_tr_b16 v[60:61], v4 offset:51200
    ds_read_b64_tr_b16 v[62:63], v4 offset:52224
    s_waitcnt lgkmcnt(4)
    v_mfma_f32_32x32x16_bf16 v[112:127], v[52:55], v[240:243], v[112:127]
    ds_read_b64_tr_b16 v[48:49], v3 offset:0
    ds_read_b64_tr_b16 v[50:51], v3 offset:1024
    s_add_u32 s86, s12, 118784
    buffer_load_dwordx4 v[160:163], v13, s[40:43], s86 offen offset:0 sc1
    s_waitcnt vmcnt(7) lgkmcnt(4)
    v_mfma_f32_32x32x16_bf16 v[96:111], v[56:59], v[244:247], v[96:111]
    ds_read_b64_tr_b16 v[52:53], v5 offset:0
    ds_read_b64_tr_b16 v[54:55], v5 offset:1024
    s_waitcnt lgkmcnt(4)
    v_mfma_f32_32x32x16_bf16 v[112:127], v[60:63], v[244:247], v[112:127]
    ds_read_b64_tr_b16 v[56:57], v3 offset:2048
    ds_read_b64_tr_b16 v[58:59], v3 offset:3072
    s_add_u32 s86, s12, 118784
    buffer_load_dwordx4 v[164:167], v13, s[40:43], s86 offen offset:1024 sc1
    s_waitcnt vmcnt(7) lgkmcnt(4)
    v_mfma_f32_32x32x16_bf16 v[96:111], v[48:51], v[248:251], v[96:111]
    ds_read_b64_tr_b16 v[60:61], v5 offset:2048
    ds_read_b64_tr_b16 v[62:63], v5 offset:3072
    s_waitcnt lgkmcnt(4)
    s_barrier
    v_mfma_f32_32x32x16_bf16 v[112:127], v[52:55], v[248:251], v[112:127]
    ds_read_b64_tr_b16 v[48:49], v3 offset:16384
    ds_read_b64_tr_b16 v[50:51], v3 offset:17408
    s_add_u32 s86, s12, 118784
    buffer_load_dwordx4 v[168:171], v13, s[40:43], s86 offen offset:2048 sc1
    s_waitcnt vmcnt(7) lgkmcnt(4)
    v_mfma_f32_32x32x16_bf16 v[96:111], v[56:59], v[252:255], v[96:111]
    ds_read_b64_tr_b16 v[52:53], v5 offset:16384
    ds_read_b64_tr_b16 v[54:55], v5 offset:17408
    s_waitcnt lgkmcnt(4)
    v_mfma_f32_32x32x16_bf16 v[112:127], v[60:63], v[252:255], v[112:127]
    ds_read_b64_tr_b16 v[56:57], v3 offset:18432
    ds_read_b64_tr_b16 v[58:59], v3 offset:19456
    s_add_u32 s86, s12, 118784
    buffer_load_dwordx4 v[172:175], v13, s[40:43], s86 offen offset:3072 sc1
    s_waitcnt vmcnt(7) lgkmcnt(4)
    v_mfma_f32_32x32x16_bf16 v[96:111], v[48:51], v[144:147], v[96:111]
    ds_read_b64_tr_b16 v[60:61], v5 offset:18432
    ds_read_b64_tr_b16 v[62:63], v5 offset:19456
    s_waitcnt lgkmcnt(4)
    v_mfma_f32_32x32x16_bf16 v[112:127], v[52:55], v[144:147], v[112:127]
    ds_read_b64_tr_b16 v[48:49], v3 offset:32768
    ds_read_b64_tr_b16 v[50:51], v3 offset:33792
    s_lshl_b32 s87, s26, 3
    s_add_u32 s87, s87, s64
    s_lshl_b32 s87, s87, 13
    s_lshl_b32 s88, s27, 7
    s_add_u32 s87, s87, s88
    v_lshrrev_b32 v39, 3, v0
    v_and_b32 v35, 7, v0
    v_lshlrev_b32 v36, 10, v39
    v_lshl_add_u32 v36, v35, 4, v36
    v_add_u32 v36, s87, v36
    s_lshl_b32 s87, s64, 3
    v_add_u32 v39, s87, v39
    v_mul_u32_u24 v38, 272, v39
    v_lshl_add_u32 v38, v35, 5, v38
    v_and_b32 v39, 31, v0
    s_lshl_b32 s87, s17, 5
    v_add_u32 v39, s87, v39
    v_mul_u32_u24 v37, 272, v39
    v_lshrrev_b32 v39, 5, v0
    v_lshl_add_u32 v37, v39, 4, v37
    s_mul_i32 s87, s16, 17408
    v_add_u32 v37, s87, v37
    buffer_load_dwordx4 v[40:43], v36, s[28:31], 0 offen
    s_waitcnt vmcnt(7) lgkmcnt(4)
    v_mfma_f32_32x32x16_bf16 v[96:111], v[56:59], v[148:151], v[96:111]
    ds_read_b64_tr_b16 v[52:53], v5 offset:32768
    ds_read_b64_tr_b16 v[54:55], v5 offset:33792
    s_waitcnt lgkmcnt(4)
    v_mfma_f32_32x32x16_bf16 v[112:127], v[60:63], v[148:151], v[112:127]
    ds_read_b64_tr_b16 v[56:57], v3 offset:34816
    ds_read_b64_tr_b16 v[58:59], v3 offset:35840
    s_waitcnt vmcnt(6) lgkmcnt(4)
    v_mfma_f32_32x32x16_bf16 v[96:111], v[48:51], v[152:155], v[96:111]
    ds_read_b64_tr_b16 v[60:61], v5 offset:34816
    ds_read_b64_tr_b16 v[62:63], v5 offset:35840
    s_waitcnt lgkmcnt(4)
    s_barrier
    v_mfma_f32_32x32x16_bf16 v[112:127], v[52:55], v[152:155], v[112:127]
    ds_read_b64_tr_b16 v[48:49], v3 offset:49152
    ds_read_b64_tr_b16 v[50:51], v3 offset:50176
    s_waitcnt vmcnt(5) lgkmcnt(4)
    v_mfma_f32_32x32x16_bf16 v[96:111], v[56:59], v[156:159], v[96:111]
    ds_read_b64_tr_b16 v[52:53], v3 offset:51200
    ds_read_b64_tr_b16 v[54:55], v3 offset:52224
    s_waitcnt lgkmcnt(4)
    v_mfma_f32_32x32x16_bf16 v[112:127], v[60:63], v[156:159], v[112:127]
    ds_read_b64_tr_b16 v[56:57], v14 offset:0
    ds_read_b64_tr_b16 v[58:59], v14 offset:1024
    s_waitcnt vmcnt(4) lgkmcnt(4)
    v_mfma_f32_32x32x16_bf16 v[96:111], v[48:51], v[160:163], v[96:111]
    ds_read_b64_tr_b16 v[60:61], v14 offset:2048
    ds_read_b64_tr_b16 v[62:63], v14 offset:3072
    s_waitcnt vmcnt(3) lgkmcnt(4)
    v_mfma_f32_32x32x16_bf16 v[96:111], v[52:55], v[164:167], v[96:111]
    ds_read_b64_tr_b16 v[48:49], v5 offset:49152
    ds_read_b64_tr_b16 v[50:51], v5 offset:50176
    s_waitcnt vmcnt(2) lgkmcnt(4)
    v_mfma_f32_32x32x16_bf16 v[96:111], v[56:59], v[168:171], v[96:111]
    ds_read_b64_tr_b16 v[52:53], v5 offset:51200
    ds_read_b64_tr_b16 v[54:55], v5 offset:52224
    s_waitcnt vmcnt(1) lgkmcnt(4)
    v_mfma_f32_32x32x16_bf16 v[96:111], v[60:63], v[172:175], v[96:111]
    ds_read_b64_tr_b16 v[56:57], v6 offset:0
    ds_read_b64_tr_b16 v[58:59], v6 offset:1024
    s_waitcnt lgkmcnt(4)
    v_mfma_f32_32x32x16_bf16 v[112:127], v[48:51], v[160:163], v[112:127]
    ds_read_b64_tr_b16 v[60:61], v6 offset:2048
    ds_read_b64_tr_b16 v[62:63], v6 offset:3072
    s_waitcnt lgkmcnt(4)
    v_mfma_f32_32x32x16_bf16 v[112:127], v[52:55], v[164:167], v[112:127]
    s_waitcnt lgkmcnt(2)
    v_mfma_f32_32x32x16_bf16 v[112:127], v[56:59], v[168:171], v[112:127]
    s_nop 1
    ds_write_b128 v37, v[96:99] offset:0
    ds_write_b128 v37, v[100:103] offset:32
    s_waitcnt lgkmcnt(2)
    v_mfma_f32_32x32x16_bf16 v[112:127], v[60:63], v[172:175], v[112:127]
    ds_write_b128 v37, v[104:107] offset:64
    ds_write_b128 v37, v[108:111] offset:96
    s_nop 9
    ds_write_b128 v37, v[112:115] offset:128
    ds_write_b128 v37, v[116:119] offset:160
    ds_write_b128 v37, v[120:123] offset:192
    ds_write_b128 v37, v[124:127] offset:224
    s_waitcnt vmcnt(0)
    v_lshlrev_b32 v16, 16, v40
    v_and_b32 v17, s81, v40
    v_lshlrev_b32 v18, 16, v41
    v_and_b32 v19, s81, v41
    v_lshlrev_b32 v20, 16, v42
    v_and_b32 v21, s81, v42
    v_lshlrev_b32 v22, 16, v43
    v_and_b32 v23, s81, v43
    s_waitcnt lgkmcnt(0)
    s_barrier
    ds_read_b128 v[128:131], v38 offset:0
    ds_read_b128 v[132:135], v38 offset:16
    ds_read_b128 v[136:139], v38 offset:17408
    ds_read_b128 v[140:143], v38 offset:17424
    ds_read_b128 v[144:147], v38 offset:34816
    ds_read_b128 v[148:151], v38 offset:34832
    ds_read_b128 v[152:155], v38 offset:52224
    ds_read_b128 v[156:159], v38 offset:52240
    s_waitcnt lgkmcnt(7)
    v_add_f32 v16, v16, v128
    v_add_f32 v17, v17, v129
    v_add_f32 v18, v18, v130
    v_add_f32 v19, v19, v131
    s_waitcnt lgkmcnt(6)
    v_add_f32 v20, v20, v132
    v_add_f32 v21, v21, v133
    v_add_f32 v22, v22, v134
    v_add_f32 v23, v23, v135
    s_waitcnt lgkmcnt(5)
    v_add_f32 v16, v16, v136
    v_add_f32 v17, v17, v137
    v_add_f32 v18, v18, v138
    v_add_f32 v19, v19, v139
    s_waitcnt lgkmcnt(4)
    v_add_f32 v20, v20, v140
    v_add_f32 v21, v21, v141
    v_add_f32 v22, v22, v142
    v_add_f32 v23, v23, v143
    s_waitcnt lgkmcnt(3)
    v_add_f32 v16, v16, v144
    v_add_f32 v17, v17, v145
    v_add_f32 v18, v18, v146
    v_add_f32 v19, v19, v147
    s_waitcnt lgkmcnt(2)
    v_add_f32 v20, v20, v148
    v_add_f32 v21, v21, v149
    v_add_f32 v22, v22, v150
    v_add_f32 v23, v23, v151
    s_waitcnt lgkmcnt(1)
    v_add_f32 v16, v16, v152
    v_add_f32 v17, v17, v153
    v_add_f32 v18, v18, v154
    v_add_f32 v19, v19, v155
    s_waitcnt lgkmcnt(0)
    v_add_f32 v20, v20, v156
    v_add_f32 v21, v21, v157
    v_add_f32 v22, v22, v158
    v_add_f32 v23, v23, v159
    v_cvt_pk_bf16_f32 v24, v16, v17
    v_cvt_pk_bf16_f32 v25, v18, v19
    v_cvt_pk_bf16_f32 v26, v20, v21
    v_cvt_pk_bf16_f32 v27, v22, v23
    buffer_store_dwordx4 v[24:27], v36, s[60:63], 0 offen
    s_endpgm
L_tq:
    s_lshl_b32 s87, s68, 8
    s_add_u32 s73, s73, s87
    s_add_u32 s74, s73, 128
    ds_read_b128 v[128:131], v24 offset:0
    ds_read_b128 v[132:135], v25 offset:0
    ds_read_b128 v[136:139], v26 offset:0
    ds_read_b128 v[140:143], v27 offset:0
    ds_read_b64_tr_b16 v[48:49], v5 offset:0
    ds_read_b64_tr_b16 v[50:51], v5 offset:512
    ds_read_b64_tr_b16 v[52:53], v5 offset:2048
    ds_read_b64_tr_b16 v[54:55], v5 offset:2560
    ds_read_b64_tr_b16 v[56:57], v5 offset:4096
    ds_read_b64_tr_b16 v[58:59], v5 offset:4608
    s_waitcnt lgkmcnt(4)
    v_mfma_f32_32x32x16_bf16 v[96:111], v[48:51], v[128:131], 0
    ds_read_b128 v[144:147], v28 offset:0
    ds_read_b128 v[148:151], v29 offset:0
    ds_read_b64_tr_b16 v[60:61], v5 offset:6144
    ds_read_b64_tr_b16 v[62:63], v5 offset:6656
    v_bfe_u32 v18, v0, 4, 1
    v_lshlrev_b32 v15, 15, v18
    v_lshl_or_b32 v15, v18, 31, v15
    s_lshr_b32 s16, s64, 1
    s_waitcnt lgkmcnt(6)
    v_mfma_f32_32x32x16_bf16 v[96:111], v[52:55], v[132:135], v[96:111]
    ds_read_b128 v[152:155], v30 offset:0
    ds_read_b128 v[156:159], v31 offset:0
    ds_read_b64_tr_b16 v[48:49], v7 offset:0
    ds_read_b64_tr_b16 v[50:51], v7 offset:512
    s_and_b32 s17, s64, 1
    s_lshl_b32 s87, s27, 7
    s_lshl_b32 s88, s17, 14
    s_add_u32 s87, s87, s88
    s_lshl_b32 s88, s16, 16
    s_add_u32 s10, s87, s88
    s_waitcnt lgkmcnt(8)
    v_mfma_f32_32x32x16_bf16 v[96:111], v[56:59], v[136:139], v[96:111]
    ds_read_b128 v[160:163], v24 offset:32768
    ds_read_b64_tr_b16 v[52:53], v7 offset:2048
    ds_read_b64_tr_b16 v[54:55], v7 offset:2560
    s_add_u32 s9, s10, s88
    s_lshl_b32 s88, s88, 1
    s_add_u32 s8, s9, s88
    s_lshl_b32 s87, s26, 1
    s_add_u32 s87, s87, s17
    s_mul_i32 s87, s87, 147456
    s_waitcnt lgkmcnt(7)
    v_mfma_f32_32x32x16_bf16 v[96:111], v[60:63], v[140:143], v[96:111]
    ds_read_b128 v[164:167], v25 offset:32768
    ds_read_b64_tr_b16 v[56:57], v7 offset:4096
    ds_read_b64_tr_b16 v[58:59], v7 offset:4608
    s_lshl_b32 s88, s16, 12
    s_add_u32 s13, s87, s88
    s_add_u32 s12, s13, s88
    s_lshl_b32 s88, s88, 1
    s_add_u32 s11, s12, s88
    s_lshl_b32 s83, s67, 3
    s_waitcnt lgkmcnt(6)
    v_mfma_f32_32x32x16_bf16 v[112:127], v[48:51], v[128:131], 0
    ds_read_b128 v[168:171], v26 offset:32768
    ds_read_b64_tr_b16 v[60:61], v7 offset:6144
    ds_read_b64_tr_b16 v[62:63], v7 offset:6656
    s_add_u32 s83, s83, s64
    s_lshl_b32 s83, s83, 7
    s_add_u32 s83, s83, 20971520
    s_lshr_b32 s84, s26, 1
    s_waitcnt lgkmcnt(6)
    s_waitcnt vmcnt(0)
    s_barrier
    v_mfma_f32_32x32x16_bf16 v[112:127], v[52:55], v[132:135], v[112:127]
    ds_read_b128 v[172:175], v27 offset:32768
    ds_read_b64_tr_b16 v[48:49], v5 offset:16384
    ds_read_b64_tr_b16 v[50:51], v5 offset:16896
    s_add_u32 m0, s70, 65536
    s_add_u32 s86, s73, 458752
    buffer_load_dwordx4 v11, s[36:39], s86 offen lds
    s_lshl_b32 s84, s84, 10
    s_and_b32 s87, s26, 1
    s_lshl_b32 s87, s87, 8
    s_lshl_b32 s90, s2, 3
    s_add_u32 s19, s90, s64
    s_sub_u32 s19, s19, 1024
    v_lshlrev_b32 v84, 7, v0
    v_mov_b32 v85, 1
    s_cmp_lg_u32 s19, 0
    s_cbranch_scc1 L_noclear
    v_mov_b32 v88, 0
    v_mov_b32 v89, 0
    v_mov_b32 v90, 0
    v_mov_b32 v91, 0
    s_mov_b32 s90, 20971520
    buffer_store_dwordx4 v[88:91], v84, s[40:43], s90 offen sc1
    s_mov_b32 s90, 20979712
    buffer_store_dwordx4 v[88:91], v84, s[40:43], s90 offen sc1
    s_mov_b32 s90, 20987904
    buffer_store_dwordx4 v[88:91], v84, s[40:43], s90 offen sc1
L_noclear:
    s_waitcnt lgkmcnt(6)
    v_mfma_f32_32x32x16_bf16 v[112:127], v[56:59], v[136:139], v[112:127]
    ds_read_b128 v[176:179], v28 offset:32768
    ds_read_b64_tr_b16 v[52:53], v7 offset:16384
    ds_read_b64_tr_b16 v[54:55], v7 offset:16896
    s_add_u32 s84, s84, s87
    s_add_u32 s84, s84, 20971520
    s_lshl_b32 s85, s68, 10
    s_add_u32 s85, s85, 20987904
    s_lshl_b32 s87, s67, 2
    s_add_u32 s87, s87, s65
    s_waitcnt lgkmcnt(6)
    v_mfma_f32_32x32x16_bf16 v[112:127], v[60:63], v[140:143], v[112:127]
    ds_read_b128 v[180:183], v29 offset:32768
    ds_read_b64_tr_b16 v[56:57], v5 offset:18432
    ds_read_b64_tr_b16 v[58:59], v5 offset:18944
    s_mul_i32 s75, s87, 147456
    v_lshrrev_b32 v16, 3, v0
    v_and_b32 v17, 7, v0
    v_bfe_u32 v18, v0, 4, 1
    s_waitcnt lgkmcnt(6)
    v_mfma_f32_32x32x16_bf16 v[96:111], v[48:51], v[144:147], v[96:111]
    ds_read_b128 v[184:187], v30 offset:32768
    ds_read_b64_tr_b16 v[60:61], v7 offset:18432
    ds_read_b64_tr_b16 v[62:63], v7 offset:18944
    s_add_u32 m0, s70, 66560
    s_add_u32 s86, s73, 487424
    buffer_load_dwordx4 v11, s[36:39], s86 offen lds
    v_lshlrev_b32 v18, 2, v18
    v_xor_b32 v18, v18, v17
    s_waitcnt lgkmcnt(6)
    v_mfma_f32_32x32x16_bf16 v[112:127], v[52:55], v[144:147], v[112:127]
    ds_read_b128 v[188:191], v31 offset:32768
    ds_read_b64_tr_b16 v[48:49], v5 offset:20480
    ds_read_b64_tr_b16 v[50:51], v5 offset:20992
    v_lshlrev_b32 v1, 10, v16
    v_lshl_add_u32 v1, v18, 4, v1
    s_lshl_b32 s87, s68, 1
    s_add_u32 s87, s87, s66
    s_lshl_b32 s88, s87, 11
    s_waitcnt lgkmcnt(6)
    v_mfma_f32_32x32x16_bf16 v[96:111], v[56:59], v[148:151], v[96:111]
    v_xor_b32 v24, 0x10000, v24
    v_xor_b32 v25, 0x10000, v25
    v_xor_b32 v26, 0x10000, v26
    v_xor_b32 v27, 0x10000, v27
    v_xor_b32 v28, 0x10000, v28
    v_xor_b32 v29, 0x10000, v29
    v_xor_b32 v30, 0x10000, v30
    v_xor_b32 v31, 0x10000, v31
    ds_read_b128 v[192:195], v24 offset:0
    ds_read_b64_tr_b16 v[52:53], v7 offset:20480
    ds_read_b64_tr_b16 v[54:55], v7 offset:20992
    s_add_u32 m0, s70, 81920
    s_add_u32 s86, s73, 688128
    buffer_load_dwordx4 v11, s[36:39], s86 offen lds
    s_add_u32 s77, s75, s88
    s_add_u32 s77, s77, 114688
    s_lshl_b32 s87, s68, 2
    s_waitcnt lgkmcnt(6)
    v_mfma_f32_32x32x16_bf16 v[112:127], v[60:63], v[148:151], v[112:127]
    ds_read_b64_tr_b16 v[56:57], v5 offset:22528
    ds_read_b64_tr_b16 v[58:59], v5 offset:23040
    s_add_u32 s87, s87, s66
    s_lshl_b32 s88, s87, 11
    s_add_u32 s75, s75, s88
    s_add_u32 s76, s75, 4096
    s_mul_i32 s78, s68, 69632
    s_add_u32 s78, s78, 16777216
    s_waitcnt lgkmcnt(5)
    v_mfma_f32_32x32x16_bf16 v[96:111], v[48:51], v[152:155], v[96:111]
    ds_read_b128 v[196:199], v25 offset:0
    ds_read_b64_tr_b16 v[60:61], v7 offset:22528
    ds_read_b64_tr_b16 v[62:63], v7 offset:23040
    s_add_u32 m0, s70, 82944
    s_add_u32 s86, s73, 716800
    buffer_load_dwordx4 v11, s[36:39], s86 offen lds
    s_waitcnt lgkmcnt(5)
    s_waitcnt vmcnt(2)
    s_barrier
    v_mfma_f32_32x32x16_bf16 v[112:127], v[52:55], v[152:155], v[112:127]
    ds_read_b64_tr_b16 v[48:49], v4 offset:0
    ds_read_b64_tr_b16 v[50:51], v4 offset:512
    s_add_u32 m0, s70, 98304
    s_add_u32 s86, s73, 917504
    buffer_load_dwordx4 v11, s[36:39], s86 offen lds
    s_waitcnt lgkmcnt(5)
    v_mfma_f32_32x32x16_bf16 v[96:111], v[56:59], v[156:159], v[96:111]
    ds_read_b128 v[200:203], v26 offset:0
    ds_read_b64_tr_b16 v[52:53], v6 offset:0
    ds_read_b64_tr_b16 v[54:55], v6 offset:512
    s_waitcnt lgkmcnt(5)
    v_mfma_f32_32x32x16_bf16 v[112:127], v[60:63], v[156:159], v[112:127]
    ds_read_b64_tr_b16 v[56:57], v4 offset:2048
    ds_read_b64_tr_b16 v[58:59], v4 offset:2560
    s_waitcnt lgkmcnt(5)
    v_mfma_f32_32x32x16_bf16 v[96:111], v[48:51], v[160:163], v[96:111]
    ds_read_b128 v[204:207], v27 offset:0
    ds_read_b64_tr_b16 v[60:61], v6 offset:2048
    ds_read_b64_tr_b16 v[62:63], v6 offset:2560
    s_add_u32 m0, s70, 99328
    s_add_u32 s86, s73, 946176
    buffer_load_dwordx4 v11, s[36:39], s86 offen lds
    v_bfe_u32 v16, v0, 2, 2
    v_lshrrev_b32 v17, 5, v0
    s_waitcnt lgkmcnt(5)
    v_mfma_f32_32x32x16_bf16 v[112:127], v[52:55], v[160:163], v[112:127]
    ds_read_b64_tr_b16 v[48:49], v4 offset:4096
    ds_read_b64_tr_b16 v[50:51], v4 offset:4608
    v_lshl_add_u32 v16, v17, 2, v16
    v_bfe_u32 v17, v0, 3, 2
    v_lshrrev_b32 v18, 1, v17
    v_and_b32 v17, 1, v17
    s_waitcnt lgkmcnt(5)
    v_mfma_f32_32x32x16_bf16 v[96:111], v[56:59], v[164:167], v[96:111]
    ds_read_b128 v[208:211], v28 offset:0
    ds_read_b64_tr_b16 v[52:53], v6 offset:4096
    ds_read_b64_tr_b16 v[54:55], v6 offset:4608
    s_add_u32 m0, s70, 114688
    s_add_u32 s86, s73, 1146880
    buffer_load_dwordx4 v11, s[36:39], s86 offen lds
    v_lshlrev_b32 v17, 6, v17
    v_lshl_or_b32 v17, v18, 5, v17
    s_waitcnt lgkmcnt(5)
    v_mfma_f32_32x32x16_bf16 v[112:127], v[60:63], v[164:167], v[112:127]
    ds_read_b64_tr_b16 v[56:57], v4 offset:6144
    ds_read_b64_tr_b16 v[58:59], v4 offset:6656
    v_and_b32 v18, 3, v0
    v_lshl_add_u32 v17, v18, 3, v17
    s_lshl_b32 s87, s16, 12
    s_add_u32 s87, s87, 16384
    s_waitcnt lgkmcnt(5)
    v_mfma_f32_32x32x16_bf16 v[96:111], v[48:51], v[168:171], v[96:111]
    ds_read_b128 v[212:215], v29 offset:0
    ds_read_b64_tr_b16 v[60:61], v6 offset:6144
    ds_read_b64_tr_b16 v[62:63], v6 offset:6656
    s_add_u32 m0, s70, 115712
    s_add_u32 s86, s73, 1175552
    buffer_load_dwordx4 v11, s[36:39], s86 offen lds
    v_lshl_add_u32 v8, v16, 7, v17
    v_add_u32 v8, s87, v8
    s_waitcnt lgkmcnt(5)
    s_waitcnt vmcnt(4)
    s_barrier
    v_mfma_f32_32x32x16_bf16 v[112:127], v[52:55], v[168:171], v[112:127]
    ds_read_b64_tr_b16 v[48:49], v4 offset:16384
    ds_read_b64_tr_b16 v[50:51], v4 offset:16896
    s_add_u32 m0, s70, 131072
    s_add_u32 s86, s73, 1376256
    buffer_load_dwordx4 v11, s[36:39], s86 offen lds
    v_xor_b32 v8, 64, v8
    v_add_u32 v9, 0x10000, v8
    s_waitcnt lgkmcnt(5)
    v_mfma_f32_32x32x16_bf16 v[96:111], v[56:59], v[172:175], v[96:111]
    ds_read_b128 v[216:219], v30 offset:0
    ds_read_b64_tr_b16 v[52:53], v6 offset:16384
    ds_read_b64_tr_b16 v[54:55], v6 offset:16896
    s_waitcnt lgkmcnt(5)
    v_mfma_f32_32x32x16_bf16 v[112:127], v[60:63], v[172:175], v[112:127]
    ds_read_b64_tr_b16 v[56:57], v4 offset:18432
    ds_read_b64_tr_b16 v[58:59], v4 offset:18944
    s_waitcnt lgkmcnt(5)
    v_mfma_f32_32x32x16_bf16 v[96:111], v[48:51], v[176:179], v[96:111]
    ds_read_b128 v[220:223], v31 offset:0
    ds_read_b64_tr_b16 v[60:61], v6 offset:18432
    ds_read_b64_tr_b16 v[62:63], v6 offset:18944
    s_add_u32 m0, s70, 132096
    s_add_u32 s86, s73, 1404928
    buffer_load_dwordx4 v11, s[36:39], s86 offen lds
    s_waitcnt lgkmcnt(5)
    v_mfma_f32_32x32x16_bf16 v[112:127], v[52:55], v[176:179], v[112:127]
    ds_read_b64_tr_b16 v[48:49], v4 offset:20480
    ds_read_b64_tr_b16 v[50:51], v4 offset:20992
    s_waitcnt lgkmcnt(5)
    v_mfma_f32_32x32x16_bf16 v[96:111], v[56:59], v[180:183], v[96:111]
    ds_read_b128 v[224:227], v24 offset:32768
    ds_read_b64_tr_b16 v[52:53], v6 offset:20480
    ds_read_b64_tr_b16 v[54:55], v6 offset:20992
    s_add_u32 m0, s70, 147456
    s_add_u32 s86, s73, 1605632
    buffer_load_dwordx4 v11, s[36:39], s86 offen lds
    s_waitcnt lgkmcnt(5)
    v_mfma_f32_32x32x16_bf16 v[112:127], v[60:63], v[180:183], v[112:127]
    ds_read_b64_tr_b16 v[56:57], v4 offset:22528
    ds_read_b64_tr_b16 v[58:59], v4 offset:23040
    s_waitcnt lgkmcnt(5)
    v_mfma_f32_32x32x16_bf16 v[96:111], v[48:51], v[184:187], v[96:111]
    ds_read_b128 v[228:231], v25 offset:32768
    ds_read_b64_tr_b16 v[60:61], v6 offset:22528
    ds_read_b64_tr_b16 v[62:63], v6 offset:23040
    s_waitcnt lgkmcnt(5)
    s_waitcnt vmcnt(5)
    s_barrier
    v_mfma_f32_32x32x16_bf16 v[112:127], v[52:55], v[184:187], v[112:127]
    ds_read_b64_tr_b16 v[48:49], v4 offset:32768
    ds_read_b64_tr_b16 v[50:51], v4 offset:33280
    s_lshr_b32 s86, s70, 1
    s_add_u32 m0, s86, 8192
    s_lshl_b32 s86, s68, 1
    s_add_u32 s86, s86, s66
    s_lshl_b32 s86, s86, 10
    buffer_load_dwordx4 v13, s[44:47], s86 offen lds
    s_cmp_lg_u32 s19, 0
    s_cbranch_scc1 L_noflag
    buffer_store_dword v85, v84, s[48:51], 0 offen sc1
L_noflag:
    s_waitcnt lgkmcnt(5)
    v_mfma_f32_32x32x16_bf16 v[96:111], v[56:59], v[188:191], v[96:111]
    ds_read_b128 v[232:235], v26 offset:32768
    ds_read_b64_tr_b16 v[52:53], v6 offset:32768
    ds_read_b64_tr_b16 v[54:55], v6 offset:33280
    s_waitcnt lgkmcnt(5)
    v_mfma_f32_32x32x16_bf16 v[112:127], v[60:63], v[188:191], v[112:127]
    ds_read_b64_tr_b16 v[56:57], v4 offset:34816
    ds_read_b64_tr_b16 v[58:59], v4 offset:35328
    s_waitcnt lgkmcnt(5)
    v_mfma_f32_32x32x16_bf16 v[96:111], v[48:51], v[192:195], v[96:111]
    ds_read_b128 v[236:239], v27 offset:32768
    ds_read_b64_tr_b16 v[60:61], v6 offset:34816
    ds_read_b64_tr_b16 v[62:63], v6 offset:35328
    s_add_u32 m0, s70, 148480
    s_add_u32 s86, s73, 1634304
    buffer_load_dwordx4 v11, s[36:39], s86 offen lds
    s_waitcnt lgkmcnt(5)
    v_mfma_f32_32x32x16_bf16 v[112:127], v[52:55], v[192:195], v[112:127]
    ds_read_b64_tr_b16 v[48:49], v4 offset:36864
    ds_read_b64_tr_b16 v[50:51], v4 offset:37376
    s_waitcnt lgkmcnt(5)
    v_mfma_f32_32x32x16_bf16 v[96:111], v[56:59], v[196:199], v[96:111]
    ds_read_b128 v[240:243], v28 offset:32768
    ds_read_b64_tr_b16 v[52:53], v6 offset:36864
    ds_read_b64_tr_b16 v[54:55], v6 offset:37376
    s_add_u32 m0, s70, 65536
    s_add_u32 s86, s71, 0
    buffer_load_dwordx4 v10, s[32:35], s86 offen lds
    s_waitcnt lgkmcnt(5)
    v_mfma_f32_32x32x16_bf16 v[112:127], v[60:63], v[196:199], v[112:127]
    ds_read_b64_tr_b16 v[56:57], v4 offset:38912
    ds_read_b64_tr_b16 v[58:59], v4 offset:39424
    s_waitcnt lgkmcnt(5)
    v_mfma_f32_32x32x16_bf16 v[96:111], v[48:51], v[200:203], v[96:111]
    ds_read_b128 v[244:247], v29 offset:32768
    ds_read_b64_tr_b16 v[60:61], v6 offset:38912
    ds_read_b64_tr_b16 v[62:63], v6 offset:39424
    s_waitcnt lgkmcnt(5)
    s_waitcnt vmcnt(6)
    s_barrier
    v_mfma_f32_32x32x16_bf16 v[112:127], v[52:55], v[200:203], v[112:127]
    ds_read_b64_tr_b16 v[48:49], v4 offset:49152
    ds_read_b64_tr_b16 v[50:51], v4 offset:49664
    s_add_u32 m0, s70, 66560
    s_add_u32 s86, s71, 24576
    buffer_load_dwordx4 v10, s[32:35], s86 offen lds
    v_bfe_u32 v12, v0, 2, 2
    v_lshrrev_b32 v16, 5, v0
    s_waitcnt lgkmcnt(5)
    v_mfma_f32_32x32x16_bf16 v[96:111], v[56:59], v[204:207], v[96:111]
    ds_read_b128 v[248:251], v30 offset:32768
    ds_read_b64_tr_b16 v[52:53], v6 offset:49152
    ds_read_b64_tr_b16 v[54:55], v6 offset:49664
    v_lshl_add_u32 v12, v16, 2, v12
    v_and_b32 v16, 3, v0
    v_lshlrev_b32 v16, 3, v16
    v_lshl_add_u32 v12, v12, 5, v16
    s_waitcnt lgkmcnt(5)
    v_mfma_f32_32x32x16_bf16 v[112:127], v[60:63], v[204:207], v[112:127]
    ds_read_b64_tr_b16 v[56:57], v4 offset:51200
    ds_read_b64_tr_b16 v[58:59], v4 offset:51712
    s_lshr_b32 s87, s70, 1
    s_add_u32 s87, s87, 8192
    v_add_u32 v12, s87, v12
    s_waitcnt lgkmcnt(5)
    v_mfma_f32_32x32x16_bf16 v[96:111], v[48:51], v[208:211], v[96:111]
    ds_read_b128 v[252:255], v31 offset:32768
    ds_read_b64_tr_b16 v[60:61], v6 offset:51200
    ds_read_b64_tr_b16 v[62:63], v6 offset:51712
    s_add_u32 m0, s70, 81920
    s_add_u32 s86, s71, 393216
    buffer_load_dwordx4 v10, s[32:35], s86 offen lds
    s_waitcnt lgkmcnt(5)
    v_mfma_f32_32x32x16_bf16 v[112:127], v[52:55], v[208:211], v[112:127]
    ds_read_b64_tr_b16 v[48:49], v4 offset:53248
    ds_read_b64_tr_b16 v[50:51], v4 offset:53760
    s_waitcnt lgkmcnt(5)
    v_mfma_f32_32x32x16_bf16 v[96:111], v[56:59], v[212:215], v[96:111]
    ds_read_b64_tr_b16 v[52:53], v6 offset:53248
    ds_read_b64_tr_b16 v[54:55], v6 offset:53760
    s_add_u32 m0, s70, 82944
    s_add_u32 s86, s71, 417792
    buffer_load_dwordx4 v10, s[32:35], s86 offen lds
    s_waitcnt lgkmcnt(4)
    v_mfma_f32_32x32x16_bf16 v[112:127], v[60:63], v[212:215], v[112:127]
    ds_read_b64_tr_b16 v[56:57], v4 offset:55296
    ds_read_b64_tr_b16 v[58:59], v4 offset:55808
    s_waitcnt lgkmcnt(4)
    v_mfma_f32_32x32x16_bf16 v[96:111], v[48:51], v[216:219], v[96:111]
    ds_read_b64_tr_b16 v[60:61], v6 offset:55296
    ds_read_b64_tr_b16 v[62:63], v6 offset:55808
    s_waitcnt vmcnt(5)
    ds_read_b64_tr_b16 v[20:21], v12 offset:0
    ds_read_b64_tr_b16 v[22:23], v12 offset:256
    s_waitcnt lgkmcnt(6)
    s_barrier
    v_mfma_f32_32x32x16_bf16 v[112:127], v[52:55], v[216:219], v[112:127]
    ds_read_b64_tr_b16 v[48:49], v5 offset:0
    ds_read_b64_tr_b16 v[50:51], v5 offset:512
    s_add_u32 m0, s70, 98304
    s_add_u32 s86, s71, 786432
    buffer_load_dwordx4 v10, s[32:35], s86 offen lds
    s_waitcnt lgkmcnt(6)
    v_mfma_f32_32x32x16_bf16 v[96:111], v[56:59], v[220:223], v[96:111]
    ds_read_b64_tr_b16 v[52:53], v7 offset:0
    ds_read_b64_tr_b16 v[54:55], v7 offset:512
    s_waitcnt lgkmcnt(5)
    v_xor_b32 v20, v15, v20
    v_xor_b32 v21, v15, v21
    s_waitcnt lgkmcnt(4)
    v_xor_b32 v22, v15, v22
    v_xor_b32 v23, v15, v23
    v_mfma_f32_32x32x16_bf16 v[112:127], v[60:63], v[220:223], v[112:127]
    ds_read_b64_tr_b16 v[56:57], v5 offset:2048
    ds_read_b64_tr_b16 v[58:59], v5 offset:2560
    s_waitcnt lgkmcnt(4)
    v_mfma_f32_32x32x16_bf16 v[96:111], v[48:51], v[224:227], v[96:111]
    ds_read_b64_tr_b16 v[60:61], v7 offset:2048
    ds_read_b64_tr_b16 v[62:63], v7 offset:2560
    s_add_u32 m0, s70, 99328
    s_add_u32 s86, s71, 811008
    buffer_load_dwordx4 v10, s[32:35], s86 offen lds
    s_waitcnt lgkmcnt(4)
    v_mfma_f32_32x32x16_bf16 v[112:127], v[52:55], v[224:227], v[112:127]
    ds_read_b64_tr_b16 v[48:49], v5 offset:4096
    ds_read_b64_tr_b16 v[50:51], v5 offset:4608
    s_waitcnt lgkmcnt(4)
    v_mfma_f32_32x32x16_bf16 v[96:111], v[56:59], v[228:231], v[96:111]
    ds_read_b64_tr_b16 v[52:53], v7 offset:4096
    ds_read_b64_tr_b16 v[54:55], v7 offset:4608
    s_add_u32 m0, s70, 16384
    s_add_u32 s86, s8, 0
    buffer_load_dwordx4 v1, s[52:55], s86 offen lds
    s_waitcnt lgkmcnt(4)
    v_mfma_f32_32x32x16_bf16 v[112:127], v[60:63], v[228:231], v[112:127]
    ds_read_b64_tr_b16 v[56:57], v5 offset:6144
    ds_read_b64_tr_b16 v[58:59], v5 offset:6656
    s_waitcnt lgkmcnt(4)
    v_mfma_f32_32x32x16_bf16 v[96:111], v[48:51], v[232:235], v[96:111]
    ds_read_b64_tr_b16 v[60:61], v7 offset:6144
    ds_read_b64_tr_b16 v[62:63], v7 offset:6656
    s_waitcnt lgkmcnt(4)
    s_waitcnt vmcnt(7)
    s_barrier
    v_mfma_f32_32x32x16_bf16 v[112:127], v[52:55], v[232:235], v[112:127]
    ds_read_b64_tr_b16 v[48:49], v5 offset:16384
    ds_read_b64_tr_b16 v[50:51], v5 offset:16896
    s_add_u32 m0, s70, 114688
    s_add_u32 s86, s71, 1179648
    buffer_load_dwordx4 v10, s[32:35], s86 offen lds
    s_waitcnt lgkmcnt(4)
    v_mfma_f32_32x32x16_bf16 v[96:111], v[56:59], v[236:239], v[96:111]
    ds_read_b64_tr_b16 v[52:53], v7 offset:16384
    ds_read_b64_tr_b16 v[54:55], v7 offset:16896
    s_waitcnt lgkmcnt(4)
    v_mfma_f32_32x32x16_bf16 v[112:127], v[60:63], v[236:239], v[112:127]
    ds_read_b64_tr_b16 v[56:57], v5 offset:18432
    ds_read_b64_tr_b16 v[58:59], v5 offset:18944
    s_waitcnt lgkmcnt(4)
    v_mfma_f32_32x32x16_bf16 v[96:111], v[48:51], v[240:243], v[96:111]
    ds_read_b64_tr_b16 v[60:61], v7 offset:18432
    ds_read_b64_tr_b16 v[62:63], v7 offset:18944
    s_add_u32 m0, s70, 115712
    s_add_u32 s86, s71, 1204224
    buffer_load_dwordx4 v10, s[32:35], s86 offen lds
    s_waitcnt lgkmcnt(4)
    v_mfma_f32_32x32x16_bf16 v[112:127], v[52:55], v[240:243], v[112:127]
    ds_read_b64_tr_b16 v[48:49], v5 offset:20480
    ds_read_b64_tr_b16 v[50:51], v5 offset:20992
    s_waitcnt lgkmcnt(4)
    v_mfma_f32_32x32x16_bf16 v[96:111], v[56:59], v[244:247], v[96:111]
    ds_read_b64_tr_b16 v[52:53], v7 offset:20480
    ds_read_b64_tr_b16 v[54:55], v7 offset:20992
    s_add_u32 m0, s70, 17408
    s_add_u32 s86, s8, 8192
    buffer_load_dwordx4 v1, s[52:55], s86 offen lds
    s_waitcnt lgkmcnt(4)
    v_mfma_f32_32x32x16_bf16 v[112:127], v[60:63], v[244:247], v[112:127]
    ds_read_b64_tr_b16 v[56:57], v5 offset:22528
    ds_read_b64_tr_b16 v[58:59], v5 offset:23040
    s_waitcnt lgkmcnt(4)
    v_mfma_f32_32x32x16_bf16 v[96:111], v[48:51], v[248:251], v[96:111]
    ds_read_b64_tr_b16 v[60:61], v7 offset:22528
    ds_read_b64_tr_b16 v[62:63], v7 offset:23040
    s_waitcnt lgkmcnt(4)
    s_waitcnt vmcnt(8)
    s_barrier
    v_mfma_f32_32x32x16_bf16 v[112:127], v[52:55], v[248:251], v[112:127]
    ds_read_b64_tr_b16 v[48:49], v2 offset:0
    ds_read_b64_tr_b16 v[50:51], v2 offset:512
    s_add_u32 m0, s70, 131072
    s_add_u32 s86, s74, 0
    buffer_load_dwordx4 v11, s[36:39], s86 offen lds
    s_waitcnt lgkmcnt(4)
    v_mfma_f32_32x32x16_bf16 v[96:111], v[56:59], v[252:255], v[96:111]
    ds_read_b64_tr_b16 v[52:53], v2 offset:2048
    ds_read_b64_tr_b16 v[54:55], v2 offset:2560
    s_waitcnt lgkmcnt(4)
    v_mfma_f32_32x32x16_bf16 v[112:127], v[60:63], v[252:255], v[112:127]
    ds_read_b64_tr_b16 v[56:57], v2 offset:4096
    ds_read_b64_tr_b16 v[58:59], v2 offset:4608
    s_waitcnt lgkmcnt(4)
    v_mfma_f32_32x32x16_bf16 v[64:79], v[48:51], v[128:131], 0
    ds_read_b64_tr_b16 v[60:61], v2 offset:6144
    ds_read_b64_tr_b16 v[62:63], v2 offset:6656
    s_add_u32 m0, s70, 132096
    s_add_u32 s86, s74, 28672
    buffer_load_dwordx4 v11, s[36:39], s86 offen lds
    s_waitcnt lgkmcnt(4)
    v_mfma_f32_32x32x16_bf16 v[64:79], v[52:55], v[132:135], v[64:79]
    ds_read_b64_tr_b16 v[48:49], v2 offset:8192
    ds_read_b64_tr_b16 v[50:51], v2 offset:8704
    s_waitcnt lgkmcnt(4)
    v_mfma_f32_32x32x16_bf16 v[64:79], v[56:59], v[136:139], v[64:79]
    ds_read_b64_tr_b16 v[52:53], v2 offset:10240
    ds_read_b64_tr_b16 v[54:55], v2 offset:10752
    s_add_u32 m0, s70, 32768
    s_add_u32 s86, s8, 32768
    buffer_load_dwordx4 v1, s[52:55], s86 offen lds
    v_mul_f32 v32, s80, v96
    v_mul_f32 v33, s80, v97
    v_mul_f32 v34, s80, v98
    s_waitcnt lgkmcnt(4)
    v_mfma_f32_32x32x16_bf16 v[64:79], v[60:63], v[140:143], v[64:79]
    ds_read_b64_tr_b16 v[56:57], v2 offset:12288
    ds_read_b64_tr_b16 v[58:59], v2 offset:12800
    v_mul_f32 v35, s80, v99
    v_mul_f32 v36, s80, v100
    v_mul_f32 v37, s80, v101
    v_mul_f32 v38, s80, v102
    v_mul_f32 v39, s80, v103
    s_waitcnt lgkmcnt(4)
    v_mfma_f32_32x32x16_bf16 v[64:79], v[48:51], v[144:147], v[64:79]
    ds_read_b64_tr_b16 v[60:61], v2 offset:14336
    ds_read_b64_tr_b16 v[62:63], v2 offset:14848
    v_exp_f32 v32, v32
    v_mul_f32 v104, v96, v104
    s_waitcnt lgkmcnt(4)
    s_waitcnt vmcnt(9)
    s_barrier
    v_mfma_f32_32x32x16_bf16 v[64:79], v[52:55], v[148:151], v[64:79]
    ds_read_b64_tr_b16 v[48:49], v2 offset:16384
    ds_read_b64_tr_b16 v[50:51], v2 offset:16896
    s_add_u32 m0, s70, 147456
    s_add_u32 s86, s74, 229376
    buffer_load_dwordx4 v11, s[36:39], s86 offen lds
    v_exp_f32 v33, v33
    v_mul_f32 v105, v97, v105
    s_waitcnt lgkmcnt(4)
    v_mfma_f32_32x32x16_bf16 v[64:79], v[56:59], v[152:155], v[64:79]
    ds_read_b64_tr_b16 v[52:53], v2 offset:18432
    ds_read_b64_tr_b16 v[54:55], v2 offset:18944
    v_exp_f32 v34, v34
    v_mul_f32 v106, v98, v106
    v_exp_f32 v35, v35
    v_mul_f32 v107, v99, v107
    s_waitcnt lgkmcnt(4)
    v_mfma_f32_32x32x16_bf16 v[64:79], v[60:63], v[156:159], v[64:79]
    ds_read_b64_tr_b16 v[56:57], v2 offset:20480
    ds_read_b64_tr_b16 v[58:59], v2 offset:20992
    v_exp_f32 v36, v36
    v_mul_f32 v108, v100, v108
    v_exp_f32 v37, v37
    v_mul_f32 v109, v101, v109
    v_lshlrev_b32 v80, 24, v0
    s_mov_b32 s20, 0
    s_cmp_lg_u32 s64, 0
    s_cbranch_scc1 L_nos_14
    buffer_load_dword v81, v80, s[48:51], s20 offen offset:0 sc1
L_nos_14:
    s_waitcnt lgkmcnt(4)
    v_mfma_f32_32x32x16_bf16 v[64:79], v[48:51], v[160:163], v[64:79]
    ds_read_b64_tr_b16 v[60:61], v2 offset:22528
    ds_read_b64_tr_b16 v[62:63], v2 offset:23040
    s_add_u32 m0, s70, 148480
    s_add_u32 s86, s74, 258048
    buffer_load_dwordx4 v11, s[36:39], s86 offen lds
    v_exp_f32 v38, v38
    v_mul_f32 v110, v102, v110
    s_waitcnt lgkmcnt(4)
    v_mfma_f32_32x32x16_bf16 v[64:79], v[52:55], v[164:167], v[64:79]
    ds_read_b64_tr_b16 v[48:49], v2 offset:24576
    ds_read_b64_tr_b16 v[50:51], v2 offset:25088
    v_exp_f32 v39, v39
    v_mul_f32 v111, v103, v111
    v_add_f32 v32, 1.0, v32
    v_add_f32 v33, 1.0, v33
    v_add_f32 v34, 1.0, v34
    s_waitcnt lgkmcnt(4)
    v_mfma_f32_32x32x16_bf16 v[64:79], v[56:59], v[168:171], v[64:79]
    ds_read_b64_tr_b16 v[52:53], v2 offset:26624
    ds_read_b64_tr_b16 v[54:55], v2 offset:27136
    s_add_u32 m0, s70, 33792
    s_add_u32 s86, s8, 40960
    buffer_load_dwordx4 v1, s[52:55], s86 offen lds
    v_add_f32 v35, 1.0, v35
    v_add_f32 v36, 1.0, v36
    v_add_f32 v37, 1.0, v37
    s_waitcnt lgkmcnt(4)
    v_mfma_f32_32x32x16_bf16 v[64:79], v[60:63], v[172:175], v[64:79]
    ds_read_b64_tr_b16 v[56:57], v2 offset:28672
    ds_read_b64_tr_b16 v[58:59], v2 offset:29184
    v_add_f32 v38, 1.0, v38
    v_add_f32 v39, 1.0, v39
    v_rcp_f32 v32, v32
    v_rcp_f32 v33, v33
    s_waitcnt lgkmcnt(4)
    v_mfma_f32_32x32x16_bf16 v[64:79], v[48:51], v[176:179], v[64:79]
    ds_read_b64_tr_b16 v[60:61], v2 offset:30720
    ds_read_b64_tr_b16 v[62:63], v2 offset:31232
    v_rcp_f32 v34, v34
    v_mul_f32 v104, v104, v32
    s_waitcnt lgkmcnt(4)
    s_waitcnt vmcnt(10)
    s_barrier
    v_mfma_f32_32x32x16_bf16 v[64:79], v[52:55], v[180:183], v[64:79]
    ds_read_b64_tr_b16 v[48:49], v2 offset:32768
    ds_read_b64_tr_b16 v[50:51], v2 offset:33280
    s_add_u32 m0, s70, 65536
    s_add_u32 s86, s74, 458752
    buffer_load_dwordx4 v11, s[36:39], s86 offen lds
    v_rcp_f32 v35, v35
    v_mul_f32 v105, v105, v33
    s_waitcnt lgkmcnt(4)
    v_mfma_f32_32x32x16_bf16 v[64:79], v[56:59], v[184:187], v[64:79]
    ds_read_b64_tr_b16 v[52:53], v2 offset:34816
    ds_read_b64_tr_b16 v[54:55], v2 offset:35328
    v_rcp_f32 v36, v36
    v_mul_f32 v106, v106, v34
    v_rcp_f32 v37, v37
    v_mul_f32 v107, v107, v35
    s_waitcnt lgkmcnt(4)
    v_mfma_f32_32x32x16_bf16 v[64:79], v[60:63], v[188:191], v[64:79]
    ds_read_b64_tr_b16 v[56:57], v2 offset:36864
    ds_read_b64_tr_b16 v[58:59], v2 offset:37376
    v_rcp_f32 v38, v38
    v_mul_f32 v108, v108, v36
    v_rcp_f32 v39, v39
    v_mul_f32 v109, v109, v37
    s_waitcnt lgkmcnt(4)
    v_mfma_f32_32x32x16_bf16 v[64:79], v[48:51], v[192:195], v[64:79]
    ds_read_b64_tr_b16 v[60:61], v2 offset:38912
    ds_read_b64_tr_b16 v[62:63], v2 offset:39424
    s_add_u32 m0, s70, 66560
    s_add_u32 s86, s74, 487424
    buffer_load_dwordx4 v11, s[36:39], s86 offen lds
    v_cvt_pk_bf16_f32 v96, v104, v105
    v_mul_f32 v110, v110, v38
    v_cvt_pk_bf16_f32 v97, v106, v107
    s_waitcnt lgkmcnt(4)
    v_mfma_f32_32x32x16_bf16 v[64:79], v[52:55], v[196:199], v[64:79]
    ds_read_b64_tr_b16 v[48:49], v2 offset:40960
    ds_read_b64_tr_b16 v[50:51], v2 offset:41472
    v_mul_f32 v111, v111, v39
    v_cvt_pk_bf16_f32 v98, v108, v109
    v_cvt_pk_bf16_f32 v99, v110, v111
    s_waitcnt lgkmcnt(4)
    v_mfma_f32_32x32x16_bf16 v[64:79], v[56:59], v[200:203], v[64:79]
    ds_read_b64_tr_b16 v[52:53], v2 offset:43008
    ds_read_b64_tr_b16 v[54:55], v2 offset:43520
    s_add_u32 m0, s70, 49152
    s_add_u32 s86, s8, 131072
    buffer_load_dwordx4 v1, s[52:55], s86 offen lds
    buffer_store_dwordx4 v[96:99], v13, s[40:43], s75 offen offset:0 sc1
    s_waitcnt lgkmcnt(4)
    v_mfma_f32_32x32x16_bf16 v[64:79], v[60:63], v[204:207], v[64:79]
    ds_read_b64_tr_b16 v[56:57], v2 offset:45056
    ds_read_b64_tr_b16 v[58:59], v2 offset:45568
    v_mul_f32 v40, s80, v112
    v_mul_f32 v41, s80, v113
    v_mul_f32 v42, s80, v114
    v_mul_f32 v43, s80, v115
    v_mul_f32 v44, s80, v116
    v_mul_f32 v45, s80, v117
    s_waitcnt lgkmcnt(4)
    v_mfma_f32_32x32x16_bf16 v[64:79], v[48:51], v[208:211], v[64:79]
    ds_read_b64_tr_b16 v[60:61], v2 offset:47104
    ds_read_b64_tr_b16 v[62:63], v2 offset:47616
    v_mul_f32 v46, s80, v118
    v_mul_f32 v47, s80, v119
    s_waitcnt lgkmcnt(4)
    s_waitcnt vmcnt(11)
    s_barrier
    v_mfma_f32_32x32x16_bf16 v[64:79], v[52:55], v[212:215], v[64:79]
    ds_read_b64_tr_b16 v[48:49], v2 offset:49152
    ds_read_b64_tr_b16 v[50:51], v2 offset:49664
    s_add_u32 m0, s70, 81920
    s_add_u32 s86, s74, 688128
    buffer_load_dwordx4 v11, s[36:39], s86 offen lds
    v_exp_f32 v40, v40
    v_mul_f32 v120, v112, v120
    s_waitcnt lgkmcnt(4)
    v_mfma_f32_32x32x16_bf16 v[64:79], v[56:59], v[216:219], v[64:79]
    ds_read_b64_tr_b16 v[52:53], v2 offset:51200
    ds_read_b64_tr_b16 v[54:55], v2 offset:51712
    v_exp_f32 v41, v41
    v_mul_f32 v121, v113, v121
    v_exp_f32 v42, v42
    v_mul_f32 v122, v114, v122
    s_waitcnt lgkmcnt(4)
    v_mfma_f32_32x32x16_bf16 v[64:79], v[60:63], v[220:223], v[64:79]
    ds_read_b64_tr_b16 v[56:57], v2 offset:53248
    ds_read_b64_tr_b16 v[58:59], v2 offset:53760
    v_exp_f32 v43, v43
    v_mul_f32 v123, v115, v123
    v_exp_f32 v44, v44
    v_mul_f32 v124, v116, v124
    s_waitcnt lgkmcnt(4)
    v_mfma_f32_32x32x16_bf16 v[64:79], v[48:51], v[224:227], v[64:79]
    ds_read_b64_tr_b16 v[60:61], v2 offset:55296
    ds_read_b64_tr_b16 v[62:63], v2 offset:55808
    s_add_u32 m0, s70, 82944
    s_add_u32 s86, s74, 716800
    buffer_load_dwordx4 v11, s[36:39], s86 offen lds
    v_exp_f32 v45, v45
    v_mul_f32 v125, v117, v125
    s_waitcnt lgkmcnt(4)
    v_mfma_f32_32x32x16_bf16 v[64:79], v[52:55], v[228:231], v[64:79]
    ds_read_b64_tr_b16 v[48:49], v2 offset:57344
    ds_read_b64_tr_b16 v[50:51], v2 offset:57856
    v_exp_f32 v46, v46
    v_mul_f32 v126, v118, v126
    v_exp_f32 v47, v47
    v_mul_f32 v127, v119, v127
    s_waitcnt lgkmcnt(4)
    v_mfma_f32_32x32x16_bf16 v[64:79], v[56:59], v[232:235], v[64:79]
    ds_read_b64_tr_b16 v[52:53], v2 offset:59392
    ds_read_b64_tr_b16 v[54:55], v2 offset:59904
    s_add_u32 m0, s70, 50176
    s_add_u32 s86, s8, 139264
    buffer_load_dwordx4 v1, s[52:55], s86 offen lds
    v_add_f32 v40, 1.0, v40
    v_add_f32 v41, 1.0, v41
    v_add_f32 v42, 1.0, v42
    s_waitcnt lgkmcnt(4)
    v_mfma_f32_32x32x16_bf16 v[64:79], v[60:63], v[236:239], v[64:79]
    ds_read_b64_tr_b16 v[56:57], v2 offset:61440
    ds_read_b64_tr_b16 v[58:59], v2 offset:61952
    v_add_f32 v43, 1.0, v43
    v_add_f32 v44, 1.0, v44
    v_add_f32 v45, 1.0, v45
    v_add_f32 v46, 1.0, v46
    v_add_f32 v47, 1.0, v47
    s_waitcnt lgkmcnt(4)
    v_mfma_f32_32x32x16_bf16 v[64:79], v[48:51], v[240:243], v[64:79]
    ds_read_b64_tr_b16 v[60:61], v2 offset:63488
    ds_read_b64_tr_b16 v[62:63], v2 offset:64000
    v_rcp_f32 v40, v40
    s_waitcnt lgkmcnt(4)
    s_cmp_lg_u32 s64, 0
    s_cbranch_scc1 L_ok_15
    s_waitcnt vmcnt(9)
    v_cmp_gt_u32 vcc, 1, v81
    s_nop 0
    s_mov_b32 s92, vcc_lo
    s_and_b32 s92, s92, 1
    s_cbranch_scc0 L_ok_15
    s_mov_b32 s91, 0
L_spin_16:
    buffer_load_dword v81, v80, s[48:51], s20 offen offset:0 sc1
    s_add_u32 s91, s91, 1
    s_cmp_ge_u32 s91, 0x80000
    s_cbranch_scc1 L_ok_15
    s_waitcnt vmcnt(0)

    v_cmp_gt_u32 vcc, 1, v81
    s_nop 0
    s_mov_b32 s92, vcc_lo
    s_and_b32 s92, s92, 1
    s_cbranch_scc1 L_spin_16
L_ok_15:
    s_waitcnt vmcnt(11)
    s_barrier
    v_mfma_f32_32x32x16_bf16 v[64:79], v[52:55], v[244:247], v[64:79]
    ds_read_b64_tr_b16 v[48:49], v5 offset:0
    ds_read_b64_tr_b16 v[50:51], v5 offset:512
    s_add_u32 m0, s70, 98304
    s_add_u32 s86, s74, 917504
    buffer_load_dwordx4 v11, s[36:39], s86 offen lds
    v_rcp_f32 v41, v41
    s_waitcnt lgkmcnt(4)
    v_mfma_f32_32x32x16_bf16 v[64:79], v[56:59], v[248:251], v[64:79]
    ds_read_b64_tr_b16 v[52:53], v5 offset:2048
    ds_read_b64_tr_b16 v[54:55], v5 offset:2560
    v_rcp_f32 v42, v42
    v_mul_f32 v120, v120, v40
    v_rcp_f32 v43, v43
    v_mul_f32 v121, v121, v41
    s_waitcnt lgkmcnt(4)
    v_mfma_f32_32x32x16_bf16 v[64:79], v[60:63], v[252:255], v[64:79]
    ds_read_b64_tr_b16 v[56:57], v5 offset:4096
    ds_read_b64_tr_b16 v[58:59], v5 offset:4608
    v_rcp_f32 v44, v44
    v_mul_f32 v122, v122, v42
    v_rcp_f32 v45, v45
    v_mul_f32 v123, v123, v43
    s_waitcnt lgkmcnt(4)
    v_mfma_f32_32x32x16_bf16 v[80:95], v[48:51], v[128:131], 0
    ds_read_b64_tr_b16 v[60:61], v5 offset:6144
    ds_read_b64_tr_b16 v[62:63], v5 offset:6656
    s_add_u32 m0, s70, 99328
    s_add_u32 s86, s74, 946176
    buffer_load_dwordx4 v11, s[36:39], s86 offen lds
    v_rcp_f32 v46, v46
    v_mul_f32 v124, v124, v44
    s_waitcnt lgkmcnt(4)
    v_mfma_f32_32x32x16_bf16 v[80:95], v[52:55], v[132:135], v[80:95]
    ds_read_b64_tr_b16 v[48:49], v7 offset:0
    ds_read_b64_tr_b16 v[50:51], v7 offset:512
    v_rcp_f32 v47, v47
    v_mul_f32 v125, v125, v45
    v_cvt_pk_bf16_f32 v112, v120, v121
    v_mul_f32 v126, v126, v46
    v_cvt_pk_bf16_f32 v24, v64, v65
    v_cvt_pk_bf16_f32 v25, v66, v67
    v_cvt_pk_bf16_f32 v26, v68, v69
    v_cvt_pk_bf16_f32 v27, v70, v71
    v_cvt_pk_bf16_f32 v28, v72, v73
    v_cvt_pk_bf16_f32 v29, v74, v75
    v_cvt_pk_bf16_f32 v30, v76, v77
    v_cvt_pk_bf16_f32 v31, v78, v79
    s_waitcnt lgkmcnt(4)
    v_mfma_f32_32x32x16_bf16 v[80:95], v[56:59], v[136:139], v[80:95]
    ds_read_b64_tr_b16 v[52:53], v7 offset:2048
    ds_read_b64_tr_b16 v[54:55], v7 offset:2560
    v_cvt_pk_bf16_f32 v113, v122, v123
    v_mul_f32 v127, v127, v47
    v_cvt_pk_bf16_f32 v114, v124, v125
    v_cvt_pk_bf16_f32 v115, v126, v127
    s_waitcnt lgkmcnt(4)
    v_mfma_f32_32x32x16_bf16 v[80:95], v[60:63], v[140:143], v[80:95]
    ds_read_b64_tr_b16 v[56:57], v7 offset:4096
    ds_read_b64_tr_b16 v[58:59], v7 offset:4608
    buffer_store_dwordx4 v[112:115], v13, s[40:43], s75 offen offset:1024 sc1
    v_mfma_f32_32x32x16_bf16 v[32:47], v[20:23], v[24:27], 0
    s_waitcnt lgkmcnt(4)
    v_mfma_f32_32x32x16_bf16 v[64:79], v[48:51], v[128:131], 0
    ds_read_b64_tr_b16 v[60:61], v7 offset:6144
    ds_read_b64_tr_b16 v[62:63], v7 offset:6656
    s_waitcnt lgkmcnt(4)
    s_waitcnt vmcnt(11)
    s_barrier
    v_mfma_f32_32x32x16_bf16 v[64:79], v[52:55], v[132:135], v[64:79]
    ds_read_b64_tr_b16 v[48:49], v5 offset:16384
    ds_read_b64_tr_b16 v[50:51], v5 offset:16896
    s_add_u32 m0, s70, 114688
    s_add_u32 s86, s74, 1146880
    buffer_load_dwordx4 v11, s[36:39], s86 offen lds
    ds_read_b64_tr_b16 v[20:21], v12 offset:512
    ds_read_b64_tr_b16 v[22:23], v12 offset:768
    v_max3_f32 v16, v32, v33, v34
    s_waitcnt lgkmcnt(6)
    v_mfma_f32_32x32x16_bf16 v[64:79], v[56:59], v[136:139], v[64:79]
    ds_read_b64_tr_b16 v[52:53], v7 offset:16384
    ds_read_b64_tr_b16 v[54:55], v7 offset:16896
    v_max3_f32 v17, v40, v41, v42
    v_max3_f32 v16, v16, v35, v36
    v_max3_f32 v17, v17, v43, v44
    v_max3_f32 v16, v16, v37, v38
    s_waitcnt lgkmcnt(6)
    v_mfma_f32_32x32x16_bf16 v[64:79], v[60:63], v[140:143], v[64:79]
    ds_read_b64_tr_b16 v[56:57], v5 offset:18432
    ds_read_b64_tr_b16 v[58:59], v5 offset:18944
    v_max3_f32 v17, v17, v45, v46
    v_max_f32 v16, v16, v39
    v_max_f32 v17, v17, v47
    s_nop 1
    v_permlane32_swap_b32 v16, v17
    v_max_f32 v16, v16, v17
    s_waitcnt lgkmcnt(6)
    v_mfma_f32_32x32x16_bf16 v[80:95], v[48:51], v[144:147], v[80:95]
    ds_read_b64_tr_b16 v[60:61], v7 offset:18432
    ds_read_b64_tr_b16 v[62:63], v7 offset:18944
    s_add_u32 m0, s70, 115712
    s_add_u32 s86, s74, 1175552
    buffer_load_dwordx4 v11, s[36:39], s86 offen lds
    v_mul_f32 v16, s80, v16
    v_mov_b32 v17, v16
    s_nop 1
    v_permlane32_swap_b32 v16, v17
    s_waitcnt lgkmcnt(4)
    v_mfma_f32_32x32x16_bf16 v[64:79], v[52:55], v[144:147], v[64:79]
    ds_read_b64_tr_b16 v[48:49], v5 offset:20480
    ds_read_b64_tr_b16 v[50:51], v5 offset:20992
    v_fma_f32 v32, v32, s79, v16
    v_fma_f32 v40, v40, s79, v17
    v_fma_f32 v33, v33, s79, v16
    v_fma_f32 v41, v41, s79, v17
    s_waitcnt lgkmcnt(4)
    v_mfma_f32_32x32x16_bf16 v[80:95], v[56:59], v[148:151], v[80:95]
    ds_read_b64_tr_b16 v[52:53], v7 offset:20480
    ds_read_b64_tr_b16 v[54:55], v7 offset:20992
    v_fma_f32 v34, v34, s79, v16
    v_fma_f32 v42, v42, s79, v17
    v_fma_f32 v35, v35, s79, v16
    v_xor_b32 v20, v15, v20
    s_waitcnt lgkmcnt(4)
    v_mfma_f32_32x32x16_bf16 v[64:79], v[60:63], v[148:151], v[64:79]
    ds_read_b64_tr_b16 v[56:57], v5 offset:22528
    ds_read_b64_tr_b16 v[58:59], v5 offset:23040
    v_xor_b32 v21, v15, v21
    v_xor_b32 v22, v15, v22
    v_xor_b32 v23, v15, v23
    v_fma_f32 v43, v43, s79, v17
    v_fma_f32 v36, v36, s79, v16
    s_waitcnt lgkmcnt(4)
    v_mfma_f32_32x32x16_bf16 v[80:95], v[48:51], v[152:155], v[80:95]
    ds_read_b64_tr_b16 v[60:61], v7 offset:22528
    ds_read_b64_tr_b16 v[62:63], v7 offset:23040
    v_fma_f32 v44, v44, s79, v17
    v_fma_f32 v37, v37, s79, v16
    s_waitcnt lgkmcnt(4)
    s_waitcnt vmcnt(10)
    s_barrier
    v_mfma_f32_32x32x16_bf16 v[64:79], v[52:55], v[152:155], v[64:79]
    ds_read_b64_tr_b16 v[48:49], v4 offset:0
    ds_read_b64_tr_b16 v[50:51], v4 offset:512
    s_add_u32 m0, s70, 131072
    s_add_u32 s86, s74, 1376256
    buffer_load_dwordx4 v11, s[36:39], s86 offen lds
    v_fma_f32 v45, v45, s79, v17
    v_fma_f32 v38, v38, s79, v16
    s_waitcnt lgkmcnt(4)
    v_mfma_f32_32x32x16_bf16 v[80:95], v[56:59], v[156:159], v[80:95]
    ds_read_b64_tr_b16 v[52:53], v6 offset:0
    ds_read_b64_tr_b16 v[54:55], v6 offset:512
    v_fma_f32 v46, v46, s79, v17
    v_fma_f32 v39, v39, s79, v16
    v_fma_f32 v47, v47, s79, v17
    s_waitcnt lgkmcnt(4)
    v_mfma_f32_32x32x16_bf16 v[64:79], v[60:63], v[156:159], v[64:79]
    ds_read_b64_tr_b16 v[56:57], v4 offset:2048
    ds_read_b64_tr_b16 v[58:59], v4 offset:2560
    v_exp_f32 v32, v32
    v_exp_f32 v40, v40
    v_exp_f32 v33, v33
    s_waitcnt lgkmcnt(4)
    v_mfma_f32_32x32x16_bf16 v[80:95], v[48:51], v[160:163], v[80:95]
    ds_read_b64_tr_b16 v[60:61], v6 offset:2048
    ds_read_b64_tr_b16 v[62:63], v6 offset:2560
    s_add_u32 m0, s70, 132096
    s_add_u32 s86, s74, 1404928
    buffer_load_dwordx4 v11, s[36:39], s86 offen lds
    v_exp_f32 v41, v41
    s_waitcnt lgkmcnt(4)
    v_mfma_f32_32x32x16_bf16 v[64:79], v[52:55], v[160:163], v[64:79]
    ds_read_b64_tr_b16 v[48:49], v4 offset:4096
    ds_read_b64_tr_b16 v[50:51], v4 offset:4608
    v_exp_f32 v34, v34
    v_add_f32 v18, v32, v33
    v_exp_f32 v42, v42
    v_add_f32 v19, v40, v41
    s_waitcnt lgkmcnt(4)
    v_mfma_f32_32x32x16_bf16 v[80:95], v[56:59], v[164:167], v[80:95]
    ds_read_b64_tr_b16 v[52:53], v6 offset:4096
    ds_read_b64_tr_b16 v[54:55], v6 offset:4608
    v_exp_f32 v35, v35
    v_add_f32 v18, v18, v34
    v_exp_f32 v43, v43
    v_add_f32 v19, v19, v42
    s_waitcnt lgkmcnt(4)
    v_mfma_f32_32x32x16_bf16 v[64:79], v[60:63], v[164:167], v[64:79]
    ds_read_b64_tr_b16 v[56:57], v4 offset:6144
    ds_read_b64_tr_b16 v[58:59], v4 offset:6656
    v_exp_f32 v36, v36
    v_add_f32 v18, v18, v35
    v_exp_f32 v44, v44
    v_add_f32 v19, v19, v43
    s_waitcnt lgkmcnt(4)
    v_mfma_f32_32x32x16_bf16 v[80:95], v[48:51], v[168:171], v[80:95]
    ds_read_b64_tr_b16 v[60:61], v6 offset:6144
    ds_read_b64_tr_b16 v[62:63], v6 offset:6656
    v_exp_f32 v37, v37
    v_add_f32 v18, v18, v36
    s_waitcnt lgkmcnt(4)
    s_waitcnt vmcnt(8)
    s_barrier
    v_mfma_f32_32x32x16_bf16 v[64:79], v[52:55], v[168:171], v[64:79]
    ds_read_b64_tr_b16 v[48:49], v4 offset:16384
    ds_read_b64_tr_b16 v[50:51], v4 offset:16896
    s_add_u32 m0, s70, 147456
    s_add_u32 s86, s74, 1605632
    buffer_load_dwordx4 v11, s[36:39], s86 offen lds
    v_exp_f32 v45, v45
    v_add_f32 v19, v19, v44
    s_waitcnt lgkmcnt(4)
    v_mfma_f32_32x32x16_bf16 v[80:95], v[56:59], v[172:175], v[80:95]
    ds_read_b64_tr_b16 v[52:53], v6 offset:16384
    ds_read_b64_tr_b16 v[54:55], v6 offset:16896
    v_exp_f32 v38, v38
    v_add_f32 v18, v18, v37
    v_exp_f32 v46, v46
    v_add_f32 v19, v19, v45
    s_waitcnt lgkmcnt(4)
    v_mfma_f32_32x32x16_bf16 v[64:79], v[60:63], v[172:175], v[64:79]
    ds_read_b64_tr_b16 v[56:57], v4 offset:18432
    ds_read_b64_tr_b16 v[58:59], v4 offset:18944
    v_exp_f32 v39, v39
    v_add_f32 v18, v18, v38
    v_exp_f32 v47, v47
    v_add_f32 v19, v19, v46
    s_waitcnt lgkmcnt(4)
    v_mfma_f32_32x32x16_bf16 v[80:95], v[48:51], v[176:179], v[80:95]
    ds_read_b64_tr_b16 v[60:61], v6 offset:18432
    ds_read_b64_tr_b16 v[62:63], v6 offset:18944
    s_add_u32 m0, s70, 148480
    s_add_u32 s86, s74, 1634304
    buffer_load_dwordx4 v11, s[36:39], s86 offen lds
    v_add_f32 v18, v18, v39
    v_add_f32 v19, v19, v47
    s_nop 1
    v_permlane32_swap_b32 v18, v19
    v_lshlrev_b32 v113, 24, v0
    v_mov_b32 v112, 1
    s_waitcnt vmcnt(6)
    buffer_atomic_add v112, v113, s[40:43], s83 offen offset:0 sc1
    s_waitcnt lgkmcnt(4)
    v_mfma_f32_32x32x16_bf16 v[64:79], v[52:55], v[176:179], v[64:79]
    ds_read_b64_tr_b16 v[48:49], v4 offset:20480
    ds_read_b64_tr_b16 v[50:51], v4 offset:20992
    v_add_f32 v18, v18, v19
    v_rcp_f32 v18, v18
    s_nop 0
    v_mov_b32 v19, v18
    s_nop 1
    v_permlane32_swap_b32 v18, v19
    v_mul_f32 v32, v32, v18
    s_waitcnt lgkmcnt(4)
    v_mfma_f32_32x32x16_bf16 v[80:95], v[56:59], v[180:183], v[80:95]
    ds_read_b64_tr_b16 v[52:53], v6 offset:20480
    ds_read_b64_tr_b16 v[54:55], v6 offset:20992
    v_mul_f32 v33, v33, v18
    v_mul_f32 v34, v34, v18
    v_mul_f32 v35, v35, v18
    v_mul_f32 v36, v36, v18
    v_mul_f32 v37, v37, v18
    v_mul_f32 v38, v38, v18
    s_waitcnt lgkmcnt(4)
    v_mfma_f32_32x32x16_bf16 v[64:79], v[60:63], v[180:183], v[64:79]
    ds_read_b64_tr_b16 v[56:57], v4 offset:22528
    ds_read_b64_tr_b16 v[58:59], v4 offset:23040
    v_mul_f32 v39, v39, v18
    v_cvt_pk_bf16_f32 v128, v32, v33
    v_cvt_pk_bf16_f32 v129, v34, v35
    v_cvt_pk_bf16_f32 v130, v36, v37
    v_cvt_pk_bf16_f32 v131, v38, v39
    s_waitcnt lgkmcnt(4)
    v_mfma_f32_32x32x16_bf16 v[80:95], v[48:51], v[184:187], v[80:95]
    ds_read_b64_tr_b16 v[60:61], v6 offset:22528
    ds_read_b64_tr_b16 v[62:63], v6 offset:23040
    v_mul_f32 v40, v40, v19
    v_mul_f32 v41, v41, v19
    v_mul_f32 v42, v42, v19
    s_waitcnt lgkmcnt(4)
    s_barrier
    v_and_b32 v11, 1, v0
    v_lshlrev_b32 v11, 7, v11
    v_bfe_u32 v112, v0, 1, 1
    v_lshl_or_b32 v11, v112, 9, v11
    v_lshrrev_b32 v112, 2, v0
    v_lshl_or_b32 v11, v112, 24, v11
    v_mfma_f32_32x32x16_bf16 v[64:79], v[52:55], v[184:187], v[64:79]
    ds_read_b64_tr_b16 v[48:49], v4 offset:32768
    ds_read_b64_tr_b16 v[50:51], v4 offset:33280
    s_add_u32 m0, s70, 65536
    s_add_u32 s86, s8, 163840
    buffer_load_dwordx4 v1, s[52:55], s86 offen lds
    v_mul_f32 v43, v43, v19
    v_mul_f32 v44, v44, v19
    v_mul_f32 v45, v45, v19
    s_waitcnt lgkmcnt(4)
    v_mfma_f32_32x32x16_bf16 v[80:95], v[56:59], v[188:191], v[80:95]
    ds_read_b64_tr_b16 v[52:53], v6 offset:32768
    ds_read_b64_tr_b16 v[54:55], v6 offset:33280
    v_mul_f32 v46, v46, v19
    v_mul_f32 v47, v47, v19
    v_cvt_pk_bf16_f32 v132, v40, v41
    v_cvt_pk_bf16_f32 v133, v42, v43
    v_cvt_pk_bf16_f32 v134, v44, v45
    s_waitcnt lgkmcnt(4)
    v_mfma_f32_32x32x16_bf16 v[64:79], v[60:63], v[188:191], v[64:79]
    ds_read_b64_tr_b16 v[56:57], v4 offset:34816
    ds_read_b64_tr_b16 v[58:59], v4 offset:35328
    v_cvt_pk_bf16_f32 v135, v46, v47
    v_mfma_f32_32x32x16_bf16 v[32:47], v[20:23], v[28:31], 0
    s_waitcnt lgkmcnt(4)
    v_mfma_f32_32x32x16_bf16 v[80:95], v[48:51], v[192:195], v[80:95]
    ds_read_b64_tr_b16 v[60:61], v6 offset:34816
    ds_read_b64_tr_b16 v[62:63], v6 offset:35328
    s_add_u32 m0, s70, 66560
    s_add_u32 s86, s8, 172032
    buffer_load_dwordx4 v1, s[52:55], s86 offen lds
    s_waitcnt lgkmcnt(4)
    v_mfma_f32_32x32x16_bf16 v[64:79], v[52:55], v[192:195], v[64:79]
    ds_read_b64_tr_b16 v[48:49], v4 offset:36864
    ds_read_b64_tr_b16 v[50:51], v4 offset:37376
    s_nop 0
    v_max3_f32 v16, v32, v33, v34
    v_max3_f32 v17, v40, v41, v42
    v_max3_f32 v16, v16, v35, v36
    v_max3_f32 v17, v17, v43, v44
    s_waitcnt lgkmcnt(4)
    v_mfma_f32_32x32x16_bf16 v[80:95], v[56:59], v[196:199], v[80:95]
    ds_read_b64_tr_b16 v[52:53], v6 offset:36864
    ds_read_b64_tr_b16 v[54:55], v6 offset:37376
    v_max3_f32 v16, v16, v37, v38
    v_max3_f32 v17, v17, v45, v46
    v_max_f32 v16, v16, v39
    v_max_f32 v17, v17, v47
    s_nop 1
    v_permlane32_swap_b32 v16, v17
    s_waitcnt lgkmcnt(4)
    v_mfma_f32_32x32x16_bf16 v[64:79], v[60:63], v[196:199], v[64:79]
    ds_read_b64_tr_b16 v[56:57], v4 offset:38912
    ds_read_b64_tr_b16 v[58:59], v4 offset:39424
    v_max_f32 v16, v16, v17
    v_mul_f32 v16, s80, v16
    v_mov_b32 v17, v16
    s_nop 1
    v_permlane32_swap_b32 v16, v17
    v_fma_f32 v32, v32, s79, v16
    s_waitcnt lgkmcnt(4)
    v_mfma_f32_32x32x16_bf16 v[80:95], v[48:51], v[200:203], v[80:95]
    ds_read_b64_tr_b16 v[60:61], v6 offset:38912
    ds_read_b64_tr_b16 v[62:63], v6 offset:39424
    v_fma_f32 v40, v40, s79, v17
    v_fma_f32 v33, v33, s79, v16
    s_waitcnt lgkmcnt(4)
    s_waitcnt vmcnt(7)
    s_barrier
    v_mfma_f32_32x32x16_bf16 v[64:79], v[52:55], v[200:203], v[64:79]
    ds_read_b64_tr_b16 v[48:49], v4 offset:49152
    ds_read_b64_tr_b16 v[50:51], v4 offset:49664
    s_add_u32 m0, s70, 81920
    s_add_u32 s86, s9, 1048576
    buffer_load_dwordx4 v1, s[52:55], s86 offen lds
    v_fma_f32 v41, v41, s79, v17
    v_fma_f32 v34, v34, s79, v16
    s_waitcnt lgkmcnt(4)
    v_mfma_f32_32x32x16_bf16 v[80:95], v[56:59], v[204:207], v[80:95]
    ds_read_b64_tr_b16 v[52:53], v6 offset:49152
    ds_read_b64_tr_b16 v[54:55], v6 offset:49664
    v_fma_f32 v42, v42, s79, v17
    v_fma_f32 v35, v35, s79, v16
    v_fma_f32 v43, v43, s79, v17
    v_fma_f32 v36, v36, s79, v16
    s_waitcnt lgkmcnt(4)
    v_mfma_f32_32x32x16_bf16 v[64:79], v[60:63], v[204:207], v[64:79]
    ds_read_b64_tr_b16 v[56:57], v4 offset:51200
    ds_read_b64_tr_b16 v[58:59], v4 offset:51712
    v_fma_f32 v44, v44, s79, v17
    v_fma_f32 v37, v37, s79, v16
    v_fma_f32 v45, v45, s79, v17
    v_fma_f32 v38, v38, s79, v16
    s_waitcnt lgkmcnt(4)
    v_mfma_f32_32x32x16_bf16 v[80:95], v[48:51], v[208:211], v[80:95]
    ds_read_b64_tr_b16 v[60:61], v6 offset:51200
    ds_read_b64_tr_b16 v[62:63], v6 offset:51712
    s_add_u32 m0, s70, 82944
    s_add_u32 s86, s9, 1056768
    buffer_load_dwordx4 v1, s[52:55], s86 offen lds
    v_fma_f32 v46, v46, s79, v17
    v_fma_f32 v39, v39, s79, v16
    s_waitcnt lgkmcnt(4)
    v_mfma_f32_32x32x16_bf16 v[64:79], v[52:55], v[208:211], v[64:79]
    ds_read_b64_tr_b16 v[48:49], v4 offset:53248
    ds_read_b64_tr_b16 v[50:51], v4 offset:53760
    v_fma_f32 v47, v47, s79, v17
    v_exp_f32 v32, v32
    v_exp_f32 v40, v40
    s_cmp_lg_u32 s64, 0
    s_cbranch_scc1 L_nos_17
    buffer_load_dword v120, v11, s[40:43], s84 offen offset:0 sc1
L_nos_17:
    s_waitcnt lgkmcnt(4)
    v_mfma_f32_32x32x16_bf16 v[80:95], v[56:59], v[212:215], v[80:95]
    ds_read_b64_tr_b16 v[52:53], v6 offset:53248
    ds_read_b64_tr_b16 v[54:55], v6 offset:53760
    v_exp_f32 v33, v33
    v_exp_f32 v41, v41
    v_exp_f32 v34, v34
    s_waitcnt lgkmcnt(4)
    v_mfma_f32_32x32x16_bf16 v[64:79], v[60:63], v[212:215], v[64:79]
    ds_read_b64_tr_b16 v[56:57], v4 offset:55296
    ds_read_b64_tr_b16 v[58:59], v4 offset:55808
    v_add_f32 v18, v32, v33
    v_exp_f32 v42, v42
    v_add_f32 v19, v40, v41
    v_exp_f32 v35, v35
    s_waitcnt lgkmcnt(4)
    v_mfma_f32_32x32x16_bf16 v[80:95], v[48:51], v[216:219], v[80:95]
    ds_read_b64_tr_b16 v[60:61], v6 offset:55296
    ds_read_b64_tr_b16 v[62:63], v6 offset:55808
    v_add_f32 v18, v18, v34
    v_exp_f32 v43, v43
    s_waitcnt lgkmcnt(4)
    s_waitcnt vmcnt(7)
    s_barrier
    v_mfma_f32_32x32x16_bf16 v[64:79], v[52:55], v[216:219], v[64:79]
    ds_read_b64_tr_b16 v[48:49], v5 offset:0
    ds_read_b64_tr_b16 v[50:51], v5 offset:512
    s_add_u32 m0, s70, 98304
    s_add_u32 s86, s9, 1081344
    buffer_load_dwordx4 v1, s[52:55], s86 offen lds
    v_add_f32 v19, v19, v42
    v_exp_f32 v36, v36
    s_waitcnt lgkmcnt(4)
    v_mfma_f32_32x32x16_bf16 v[80:95], v[56:59], v[220:223], v[80:95]
    ds_read_b64_tr_b16 v[52:53], v7 offset:0
    ds_read_b64_tr_b16 v[54:55], v7 offset:512
    v_add_f32 v18, v18, v35
    v_exp_f32 v44, v44
    v_add_f32 v19, v19, v43
    v_exp_f32 v37, v37
    s_waitcnt lgkmcnt(4)
    v_mfma_f32_32x32x16_bf16 v[64:79], v[60:63], v[220:223], v[64:79]
    ds_read_b64_tr_b16 v[56:57], v5 offset:2048
    ds_read_b64_tr_b16 v[58:59], v5 offset:2560
    v_add_f32 v18, v18, v36
    v_exp_f32 v45, v45
    v_add_f32 v19, v19, v44
    v_exp_f32 v38, v38
    s_waitcnt lgkmcnt(4)
    v_mfma_f32_32x32x16_bf16 v[80:95], v[48:51], v[224:227], v[80:95]
    ds_read_b64_tr_b16 v[60:61], v7 offset:2048
    ds_read_b64_tr_b16 v[62:63], v7 offset:2560
    s_add_u32 m0, s70, 99328
    s_add_u32 s86, s9, 1089536
    buffer_load_dwordx4 v1, s[52:55], s86 offen lds
    v_add_f32 v18, v18, v37
    v_exp_f32 v46, v46
    s_waitcnt lgkmcnt(4)
    v_mfma_f32_32x32x16_bf16 v[64:79], v[52:55], v[224:227], v[64:79]
    ds_read_b64_tr_b16 v[48:49], v5 offset:4096
    ds_read_b64_tr_b16 v[50:51], v5 offset:4608
    v_add_f32 v19, v19, v45
    v_exp_f32 v39, v39
    v_add_f32 v18, v18, v38
    v_exp_f32 v47, v47
    s_waitcnt lgkmcnt(4)
    v_mfma_f32_32x32x16_bf16 v[80:95], v[56:59], v[228:231], v[80:95]
    ds_read_b64_tr_b16 v[52:53], v7 offset:4096
    ds_read_b64_tr_b16 v[54:55], v7 offset:4608
    v_add_f32 v19, v19, v46
    v_add_f32 v18, v18, v39
    v_add_f32 v19, v19, v47
    s_nop 1
    v_permlane32_swap_b32 v18, v19
    v_add_f32 v18, v18, v19
    s_waitcnt lgkmcnt(4)
    v_mfma_f32_32x32x16_bf16 v[64:79], v[60:63], v[228:231], v[64:79]
    ds_read_b64_tr_b16 v[56:57], v5 offset:6144
    ds_read_b64_tr_b16 v[58:59], v5 offset:6656
    v_rcp_f32 v18, v18
    s_nop 0
    v_mov_b32 v19, v18
    s_nop 1
    v_permlane32_swap_b32 v18, v19
    v_mul_f32 v32, v32, v18
    v_mul_f32 v33, v33, v18
    s_waitcnt lgkmcnt(4)
    v_mfma_f32_32x32x16_bf16 v[80:95], v[48:51], v[232:235], v[80:95]
    ds_read_b64_tr_b16 v[60:61], v7 offset:6144
    ds_read_b64_tr_b16 v[62:63], v7 offset:6656
    v_mul_f32 v34, v34, v18
    v_mul_f32 v35, v35, v18
    v_mul_f32 v36, v36, v18
    s_waitcnt lgkmcnt(4)
    s_cmp_lg_u32 s64, 0
    s_cbranch_scc1 L_ok_18
    s_waitcnt vmcnt(2)
    v_cmp_gt_u32 vcc, 8, v120
    s_nop 0
    s_mov_b32 s92, vcc_lo
    s_and_b32 s92, s92, 15
    s_cbranch_scc0 L_ok_18
    s_mov_b32 s91, 0
L_spin_19:
    buffer_load_dword v120, v11, s[40:43], s84 offen offset:0 sc1
    s_add_u32 s91, s91, 1
    s_cmp_ge_u32 s91, 0x80000
    s_cbranch_scc1 L_ok_18
    s_waitcnt vmcnt(0)

    v_cmp_gt_u32 vcc, 8, v120
    s_nop 0
    s_mov_b32 s92, vcc_lo
    s_and_b32 s92, s92, 15
    s_cbranch_scc1 L_spin_19
L_ok_18:
    s_waitcnt vmcnt(7)
    s_barrier
    v_mfma_f32_32x32x16_bf16 v[64:79], v[52:55], v[232:235], v[64:79]
    ds_read_b64_tr_b16 v[48:49], v5 offset:16384
    ds_read_b64_tr_b16 v[50:51], v5 offset:16896
    s_add_u32 s86, s11, 0
    buffer_load_dwordx4 v[144:147], v13, s[40:43], s86 offen offset:0 sc1
    v_mul_f32 v37, v37, v18
    v_mul_f32 v38, v38, v18
    v_mul_f32 v39, v39, v18
    v_xor_b32 v2, 64, v8
    v_xor_b32 v3, 64, v9
    v_add_u32 v12, 0x20000, v8
    v_add_u32 v10, 0x20000, v2
    s_waitcnt lgkmcnt(4)
    v_mfma_f32_32x32x16_bf16 v[80:95], v[56:59], v[236:239], v[80:95]
    ds_read_b64_tr_b16 v[52:53], v7 offset:16384
    ds_read_b64_tr_b16 v[54:55], v7 offset:16896
    s_add_u32 s86, s11, 0
    buffer_load_dwordx4 v[148:151], v13, s[40:43], s86 offen offset:1024 sc1
    v_cvt_pk_bf16_f32 v136, v32, v33
    v_cvt_pk_bf16_f32 v137, v34, v35
    v_cvt_pk_bf16_f32 v138, v36, v37
    s_waitcnt lgkmcnt(4)
    v_mfma_f32_32x32x16_bf16 v[64:79], v[60:63], v[236:239], v[64:79]
    ds_read_b64_tr_b16 v[56:57], v5 offset:18432
    ds_read_b64_tr_b16 v[58:59], v5 offset:18944
    s_add_u32 s86, s11, 0
    buffer_load_dwordx4 v[152:155], v13, s[40:43], s86 offen offset:2048 sc1
    v_cvt_pk_bf16_f32 v139, v38, v39
    v_mul_f32 v40, v40, v19
    v_mul_f32 v41, v41, v19
    s_waitcnt lgkmcnt(4)
    v_mfma_f32_32x32x16_bf16 v[80:95], v[48:51], v[240:243], v[80:95]
    ds_read_b64_tr_b16 v[60:61], v7 offset:18432
    ds_read_b64_tr_b16 v[62:63], v7 offset:18944
    s_add_u32 s86, s11, 0
    buffer_load_dwordx4 v[156:159], v13, s[40:43], s86 offen offset:3072 sc1
    v_mul_f32 v42, v42, v19
    v_mul_f32 v43, v43, v19
    v_mul_f32 v44, v44, v19
    s_waitcnt lgkmcnt(4)
    v_mfma_f32_32x32x16_bf16 v[64:79], v[52:55], v[240:243], v[64:79]
    ds_read_b64_tr_b16 v[48:49], v5 offset:20480
    ds_read_b64_tr_b16 v[50:51], v5 offset:20992
    s_add_u32 s86, s11, 8192
    buffer_load_dwordx4 v[160:163], v13, s[40:43], s86 offen offset:0 sc1
    v_mul_f32 v45, v45, v19
    v_mul_f32 v46, v46, v19
    v_mul_f32 v47, v47, v19
    s_waitcnt lgkmcnt(4)
    v_mfma_f32_32x32x16_bf16 v[80:95], v[56:59], v[244:247], v[80:95]
    ds_read_b64_tr_b16 v[52:53], v7 offset:20480
    ds_read_b64_tr_b16 v[54:55], v7 offset:20992
    s_add_u32 s86, s11, 8192
    buffer_load_dwordx4 v[164:167], v13, s[40:43], s86 offen offset:1024 sc1
    v_cvt_pk_bf16_f32 v140, v40, v41
    v_cvt_pk_bf16_f32 v141, v42, v43
    v_cvt_pk_bf16_f32 v142, v44, v45
    s_waitcnt lgkmcnt(4)
    v_mfma_f32_32x32x16_bf16 v[64:79], v[60:63], v[244:247], v[64:79]
    ds_read_b64_tr_b16 v[56:57], v5 offset:22528
    ds_read_b64_tr_b16 v[58:59], v5 offset:23040
    s_add_u32 s86, s11, 8192
    buffer_load_dwordx4 v[168:171], v13, s[40:43], s86 offen offset:2048 sc1
    v_cvt_pk_bf16_f32 v143, v46, v47
    s_cmp_lg_u32 s64, 0
    s_cbranch_scc1 L_nos_20
    buffer_load_dword v177, v11, s[40:43], s85 offen offset:0 sc1
L_nos_20:
    s_waitcnt lgkmcnt(4)
    v_mfma_f32_32x32x16_bf16 v[80:95], v[48:51], v[248:251], v[80:95]
    ds_read_b64_tr_b16 v[60:61], v7 offset:22528
    ds_read_b64_tr_b16 v[62:63], v7 offset:23040
    s_add_u32 s86, s11, 8192
    buffer_load_dwordx4 v[172:175], v13, s[40:43], s86 offen offset:3072 sc1
    s_waitcnt lgkmcnt(4)
    v_mfma_f32_32x32x16_bf16 v[64:79], v[52:55], v[248:251], v[64:79]
    s_waitcnt lgkmcnt(2)
    v_mfma_f32_32x32x16_bf16 v[80:95], v[56:59], v[252:255], v[80:95]
    s_waitcnt lgkmcnt(0)
    v_mfma_f32_32x32x16_bf16 v[64:79], v[60:63], v[252:255], v[64:79]
    s_nop 9
    v_mul_f32 v16, s80, v80
    v_mul_f32 v17, s80, v81
    v_mul_f32 v18, s80, v82
    v_mul_f32 v19, s80, v83
    v_mul_f32 v20, s80, v84
    v_mul_f32 v21, s80, v85
    v_mul_f32 v22, s80, v86
    v_mul_f32 v23, s80, v87
    v_exp_f32 v16, v16
    v_mul_f32 v88, v80, v88
    v_exp_f32 v17, v17
    v_mul_f32 v89, v81, v89
    v_exp_f32 v18, v18
    v_mul_f32 v90, v82, v90
    v_exp_f32 v19, v19
    v_mul_f32 v91, v83, v91
    v_exp_f32 v20, v20
    v_mul_f32 v92, v84, v92
    v_exp_f32 v21, v21
    v_mul_f32 v93, v85, v93
    v_exp_f32 v22, v22
    v_mul_f32 v94, v86, v94
    v_exp_f32 v23, v23
    v_mul_f32 v95, v87, v95
    v_add_f32 v16, 1.0, v16
    v_add_f32 v17, 1.0, v17
    v_add_f32 v18, 1.0, v18
    v_add_f32 v19, 1.0, v19
    v_add_f32 v20, 1.0, v20
    v_add_f32 v21, 1.0, v21
    v_add_f32 v22, 1.0, v22
    v_add_f32 v23, 1.0, v23
    v_rcp_f32 v16, v16
    v_rcp_f32 v17, v17
    v_rcp_f32 v18, v18
    v_mul_f32 v88, v88, v16
    v_rcp_f32 v19, v19
    v_mul_f32 v89, v89, v17
    v_rcp_f32 v20, v20
    v_mul_f32 v90, v90, v18
    v_rcp_f32 v21, v21
    v_mul_f32 v91, v91, v19
    v_rcp_f32 v22, v22
    v_mul_f32 v92, v92, v20
    v_rcp_f32 v23, v23
    v_mul_f32 v93, v93, v21
    v_cvt_pk_bf16_f32 v80, v88, v89
    v_mul_f32 v94, v94, v22
    v_cvt_pk_bf16_f32 v81, v90, v91
    v_mul_f32 v95, v95, v23
    v_cvt_pk_bf16_f32 v82, v92, v93
    v_cvt_pk_bf16_f32 v83, v94, v95
    buffer_store_dwordx4 v[80:83], v13, s[40:43], s76 offen offset:0 sc1
    v_mul_f32 v24, s80, v64
    v_mul_f32 v25, s80, v65
    v_mul_f32 v26, s80, v66
    v_mul_f32 v27, s80, v67
    v_mul_f32 v28, s80, v68
    v_mul_f32 v29, s80, v69
    v_mul_f32 v30, s80, v70
    v_mul_f32 v31, s80, v71
    v_exp_f32 v24, v24
    v_mul_f32 v72, v64, v72
    v_exp_f32 v25, v25
    v_mul_f32 v73, v65, v73
    v_exp_f32 v26, v26
    v_mul_f32 v74, v66, v74
    v_exp_f32 v27, v27
    v_mul_f32 v75, v67, v75
    v_exp_f32 v28, v28
    v_mul_f32 v76, v68, v76
    v_exp_f32 v29, v29
    v_mul_f32 v77, v69, v77
    v_exp_f32 v30, v30
    v_mul_f32 v78, v70, v78
    v_exp_f32 v31, v31
    v_mul_f32 v79, v71, v79
    v_add_f32 v24, 1.0, v24
    v_add_f32 v25, 1.0, v25
    v_add_f32 v26, 1.0, v26
    v_add_f32 v27, 1.0, v27
    v_add_f32 v28, 1.0, v28
    v_add_f32 v29, 1.0, v29
    v_add_f32 v30, 1.0, v30
    v_add_f32 v31, 1.0, v31
    v_rcp_f32 v24, v24
    v_rcp_f32 v25, v25
    v_rcp_f32 v26, v26
    v_mul_f32 v72, v72, v24
    v_rcp_f32 v27, v27
    v_mul_f32 v73, v73, v25
    v_rcp_f32 v28, v28
    v_mul_f32 v74, v74, v26
    v_rcp_f32 v29, v29
    v_mul_f32 v75, v75, v27
    v_rcp_f32 v30, v30
    v_mul_f32 v76, v76, v28
    v_rcp_f32 v31, v31
    v_mul_f32 v77, v77, v29
    v_cvt_pk_bf16_f32 v64, v72, v73
    v_mul_f32 v78, v78, v30
    v_cvt_pk_bf16_f32 v65, v74, v75
    v_mul_f32 v79, v79, v31
    v_cvt_pk_bf16_f32 v66, v76, v77
    v_cvt_pk_bf16_f32 v67, v78, v79
    buffer_store_dwordx4 v[64:67], v13, s[40:43], s76 offen offset:1024 sc1
    s_mul_i32 s89, s66, 34816
    s_add_u32 s89, s89, s78
    s_lshr_b32 s87, s65, 1
    s_mul_i32 s87, s87, 2176
    s_and_b32 s88, s65, 1
    s_lshl_b32 s88, s88, 10
    s_add_u32 s87, s87, s88
    v_add_u32 v26, s87, v13
    s_mov_b32 s93, 0x3f80
    s_mov_b32 s94, 0x3f800000
    s_cmp_lg_u32 s64, 0
    s_cbranch_scc1 L_ok_21
    s_waitcnt vmcnt(3)
    v_cmp_gt_u32 vcc, 16, v177
    s_nop 0
    s_mov_b32 s92, vcc_lo
    s_and_b32 s92, s92, 15
    s_cbranch_scc0 L_ok_21
    s_mov_b32 s91, 0
L_spin_22:
    buffer_load_dword v177, v11, s[40:43], s85 offen offset:0 sc1
    s_add_u32 s91, s91, 1
    s_cmp_ge_u32 s91, 0x80000
    s_cbranch_scc1 L_ok_21
    s_waitcnt vmcnt(0)

    v_cmp_gt_u32 vcc, 16, v177
    s_nop 0
    s_mov_b32 s92, vcc_lo
    s_and_b32 s92, s92, 15
    s_cbranch_scc1 L_spin_22
L_ok_21:
    s_barrier
    s_cmp_lg_u32 s65, 3
    s_cbranch_scc1 L_noz_23
    v_lshrrev_b32 v24, 4, v0
    v_mul_u32_u24 v25, 4352, v24
    v_bfe_u32 v24, v0, 3, 1
    v_mul_u32_u24 v24, 2176, v24
    v_add_u32 v25, v25, v24
    v_and_b32 v24, 7, v0
    v_lshl_add_u32 v25, v24, 4, v25
    s_add_u32 s86, s89, 17408
    buffer_load_dwordx4 v[16:19], v25, s[40:43], s89 offen offset:2048 sc1
    buffer_load_dwordx4 v[20:23], v25, s[40:43], s86 offen offset:2048 sc1
L_noz_23:
    s_add_u32 s86, s89, 0
    buffer_load_dwordx4 v[64:67], v26, s[40:43], s86 offen sc1
    s_add_u32 s86, s89, 4352
    buffer_load_dwordx4 v[68:71], v26, s[40:43], s86 offen sc1
    s_add_u32 s86, s89, 8704
    buffer_load_dwordx4 v[72:75], v26, s[40:43], s86 offen sc1
    s_add_u32 s86, s89, 13056
    buffer_load_dwordx4 v[76:79], v26, s[40:43], s86 offen sc1
    s_add_u32 s86, s89, 17408
    buffer_load_dwordx4 v[80:83], v26, s[40:43], s86 offen sc1
    s_add_u32 s86, s89, 21760
    buffer_load_dwordx4 v[84:87], v26, s[40:43], s86 offen sc1
    s_add_u32 s86, s89, 26112
    buffer_load_dwordx4 v[88:91], v26, s[40:43], s86 offen sc1
    s_add_u32 s86, s89, 30464
    buffer_load_dwordx4 v[92:95], v26, s[40:43], s86 offen sc1
    s_lshl_b32 s87, s66, 13
    s_and_b32 s88, s65, 1
    s_lshl_b32 s88, s88, 12
    s_add_u32 s87, s87, s88
    s_lshr_b32 s88, s65, 1
    s_lshl_b32 s88, s88, 10
    s_add_u32 s87, s87, s88
    v_lshrrev_b32 v178, 5, v0
    v_lshlrev_b32 v27, 11, v178
    v_bfe_u32 v25, v0, 4, 1
    v_lshl_add_u32 v27, v25, 9, v27
    v_and_b32 v25, 15, v0
    v_lshl_add_u32 v27, v25, 4, v27
    v_add_u32 v27, s87, v27
    v_and_b32 v25, 31, v0
    v_min_u32 v25, 16, v25
    v_lshl_add_u32 v178, v178, 5, v25
    v_lshlrev_b32 v178, 4, v178
    s_lshl_b32 s87, s66, 12
    v_add_u32 v178, s87, v178
    s_barrier
    ds_read_b64_tr_b16 v[48:49], v2 offset:0
    ds_read_b64_tr_b16 v[50:51], v2 offset:1024
    ds_read_b64_tr_b16 v[52:53], v8 offset:0
    ds_read_b64_tr_b16 v[54:55], v8 offset:1024
    ds_read_b64_tr_b16 v[56:57], v2 offset:2048
    ds_read_b64_tr_b16 v[58:59], v2 offset:3072
    s_waitcnt vmcnt(17) lgkmcnt(4)
    v_mfma_f32_32x32x16_bf16 v[96:111], v[48:51], v[144:147], 0
    ds_read_b64_tr_b16 v[60:61], v8 offset:2048
    ds_read_b64_tr_b16 v[62:63], v8 offset:3072
    s_add_u32 m0, s70, 114688
    s_add_u32 s86, s9, 1114112
    buffer_load_dwordx4 v1, s[52:55], s86 offen lds
    s_waitcnt lgkmcnt(4)
    v_mfma_f32_32x32x16_bf16 v[112:127], v[52:55], v[144:147], 0
    ds_read_b64_tr_b16 v[48:49], v2 offset:16384
    ds_read_b64_tr_b16 v[50:51], v2 offset:17408
    s_add_u32 m0, s70, 115712
    s_add_u32 s86, s9, 1122304
    buffer_load_dwordx4 v1, s[52:55], s86 offen lds
    s_waitcnt vmcnt(18) lgkmcnt(4)
    v_mfma_f32_32x32x16_bf16 v[96:111], v[56:59], v[148:151], v[96:111]
    ds_read_b64_tr_b16 v[52:53], v8 offset:16384
    ds_read_b64_tr_b16 v[54:55], v8 offset:17408
    s_add_u32 m0, s70, 131072
    s_add_u32 s86, s9, 1146880
    buffer_load_dwordx4 v1, s[52:55], s86 offen lds
    s_waitcnt lgkmcnt(4)
    v_mfma_f32_32x32x16_bf16 v[112:127], v[60:63], v[148:151], v[112:127]
    ds_read_b64_tr_b16 v[56:57], v2 offset:18432
    ds_read_b64_tr_b16 v[58:59], v2 offset:19456
    s_add_u32 m0, s70, 132096
    s_add_u32 s86, s9, 1155072
    buffer_load_dwordx4 v1, s[52:55], s86 offen lds
    v_lshlrev_b32 v29, 24, v0
    v_mov_b32 v28, 1
    s_waitcnt vmcnt(12)
    buffer_atomic_add v28, v29, s[40:43], s83 offen offset:8 sc1
    s_waitcnt lgkmcnt(4)
    v_mfma_f32_32x32x16_bf16 v[96:111], v[48:51], v[152:155], v[96:111]
    ds_read_b64_tr_b16 v[60:61], v8 offset:18432
    ds_read_b64_tr_b16 v[62:63], v8 offset:19456
    s_add_u32 m0, s70, 147456
    s_add_u32 s86, s8, 65536
    buffer_load_dwordx4 v1, s[52:55], s86 offen lds
    s_waitcnt lgkmcnt(4)
    s_barrier
    v_mfma_f32_32x32x16_bf16 v[112:127], v[52:55], v[152:155], v[112:127]
    ds_read_b64_tr_b16 v[48:49], v2 offset:32768
    ds_read_b64_tr_b16 v[50:51], v2 offset:33792
    s_add_u32 m0, s70, 148480
    s_add_u32 s86, s8, 73728
    buffer_load_dwordx4 v1, s[52:55], s86 offen lds
    s_waitcnt lgkmcnt(4)
    v_mfma_f32_32x32x16_bf16 v[96:111], v[56:59], v[156:159], v[96:111]
    ds_read_b64_tr_b16 v[52:53], v8 offset:32768
    ds_read_b64_tr_b16 v[54:55], v8 offset:33792
    s_waitcnt lgkmcnt(4)
    v_mfma_f32_32x32x16_bf16 v[112:127], v[60:63], v[156:159], v[112:127]
    ds_read_b64_tr_b16 v[56:57], v2 offset:34816
    ds_read_b64_tr_b16 v[58:59], v2 offset:35840
    s_waitcnt vmcnt(14)
    s_cmp_lg_u32 s65, 3
    s_cbranch_scc1 L_noz_24
    v_lshlrev_b32 v40, 16, v16
    v_and_b32 v41, s81, v16
    v_lshlrev_b32 v42, 16, v17
    v_and_b32 v43, s81, v17
    v_lshlrev_b32 v44, 16, v18
    v_and_b32 v45, s81, v18
    v_lshlrev_b32 v46, 16, v19
    v_and_b32 v47, s81, v19
    v_dot2c_f32_bf16 v40, s93, v20
    v_dot2c_f32_bf16 v41, s94, v20
    v_dot2c_f32_bf16 v42, s93, v21
    v_dot2c_f32_bf16 v43, s94, v21
    v_dot2c_f32_bf16 v44, s93, v22
    v_dot2c_f32_bf16 v45, s94, v22
    v_dot2c_f32_bf16 v46, s93, v23
    v_dot2c_f32_bf16 v47, s94, v23
    v_mov_b32 v16, v40
    v_mov_b32 v17, v41
    v_mov_b32 v18, v42
    v_mov_b32 v19, v43
    v_mov_b32 v20, v44
    v_mov_b32 v21, v45
    v_mov_b32 v22, v46
    v_mov_b32 v23, v47
    v_permlane16_swap_b32 v40, v16
    v_permlane16_swap_b32 v41, v17
    v_permlane16_swap_b32 v42, v18
    v_permlane16_swap_b32 v43, v19
    v_permlane16_swap_b32 v44, v20
    v_permlane16_swap_b32 v45, v21
    v_permlane16_swap_b32 v46, v22
    v_permlane16_swap_b32 v47, v23
    v_add_f32 v40, v40, v16
    v_add_f32 v41, v41, v17
    v_add_f32 v42, v42, v18
    v_add_f32 v43, v43, v19
    v_add_f32 v44, v44, v20
    v_add_f32 v45, v45, v21
    v_add_f32 v46, v46, v22
    v_add_f32 v47, v47, v23
    v_mov_b32 v16, v40
    v_mov_b32 v17, v41
    v_mov_b32 v18, v42
    v_mov_b32 v19, v43
    v_mov_b32 v20, v44
    v_mov_b32 v21, v45
    v_mov_b32 v22, v46
    v_mov_b32 v23, v47
    v_permlane32_swap_b32 v40, v16
    v_permlane32_swap_b32 v41, v17
    v_permlane32_swap_b32 v42, v18
    v_permlane32_swap_b32 v43, v19
    v_permlane32_swap_b32 v44, v20
    v_permlane32_swap_b32 v45, v21
    v_permlane32_swap_b32 v46, v22
    v_permlane32_swap_b32 v47, v23
    v_add_f32 v40, v40, v16
    v_add_f32 v41, v41, v17
    v_add_f32 v42, v42, v18
    v_add_f32 v43, v43, v19
    v_add_f32 v44, v44, v20
    v_add_f32 v45, v45, v21
    v_add_f32 v46, v46, v22
    v_add_f32 v47, v47, v23
    v_cvt_pk_bf16_f32 v16, v40, v41
    v_cvt_pk_bf16_f32 v17, v42, v43
    v_cvt_pk_bf16_f32 v18, v44, v45
    v_cvt_pk_bf16_f32 v19, v46, v47
    v_bfe_u32 v40, v0, 1, 2
    v_lshlrev_b32 v40, 11, v40
    v_bfe_u32 v41, v0, 3, 1
    v_lshl_add_u32 v40, v41, 10, v40
    v_and_b32 v41, 1, v0
    v_lshl_add_u32 v40, v41, 9, v40
    s_lshl_b32 s87, s66, 13
    v_add_u32 v40, s87, v40
    ds_write_b128 v40, v[16:19] offset:256
    s_waitcnt lgkmcnt(0)
L_noz_24:
    v_lshlrev_b32 v32, 16, v64
    v_and_b32 v33, s81, v64
    v_lshlrev_b32 v34, 16, v65
    v_and_b32 v35, s81, v65
    v_lshlrev_b32 v36, 16, v66
    v_and_b32 v37, s81, v66
    v_lshlrev_b32 v38, 16, v67
    v_and_b32 v39, s81, v67
    s_waitcnt vmcnt(13)
    v_dot2c_f32_bf16 v32, s93, v68
    v_dot2c_f32_bf16 v33, s94, v68
    v_dot2c_f32_bf16 v34, s93, v69
    v_dot2c_f32_bf16 v35, s94, v69
    v_dot2c_f32_bf16 v36, s93, v70
    v_dot2c_f32_bf16 v37, s94, v70
    v_dot2c_f32_bf16 v38, s93, v71
    v_dot2c_f32_bf16 v39, s94, v71
    s_waitcnt vmcnt(12)
    v_dot2c_f32_bf16 v32, s93, v72
    v_dot2c_f32_bf16 v33, s94, v72
    v_dot2c_f32_bf16 v34, s93, v73
    v_dot2c_f32_bf16 v35, s94, v73
    v_dot2c_f32_bf16 v36, s93, v74
    v_dot2c_f32_bf16 v37, s94, v74
    v_dot2c_f32_bf16 v38, s93, v75
    v_dot2c_f32_bf16 v39, s94, v75
    s_waitcnt vmcnt(11)
    v_dot2c_f32_bf16 v32, s93, v76
    v_dot2c_f32_bf16 v33, s94, v76
    v_dot2c_f32_bf16 v34, s93, v77
    v_dot2c_f32_bf16 v35, s94, v77
    v_dot2c_f32_bf16 v36, s93, v78
    v_dot2c_f32_bf16 v37, s94, v78
    v_dot2c_f32_bf16 v38, s93, v79
    v_dot2c_f32_bf16 v39, s94, v79
    s_waitcnt vmcnt(10)
    v_dot2c_f32_bf16 v32, s93, v80
    v_dot2c_f32_bf16 v33, s94, v80
    v_dot2c_f32_bf16 v34, s93, v81
    v_dot2c_f32_bf16 v35, s94, v81
    v_dot2c_f32_bf16 v36, s93, v82
    v_dot2c_f32_bf16 v37, s94, v82
    v_dot2c_f32_bf16 v38, s93, v83
    v_dot2c_f32_bf16 v39, s94, v83
    s_waitcnt vmcnt(9)
    v_dot2c_f32_bf16 v32, s93, v84
    v_dot2c_f32_bf16 v33, s94, v84
    v_dot2c_f32_bf16 v34, s93, v85
    v_dot2c_f32_bf16 v35, s94, v85
    v_dot2c_f32_bf16 v36, s93, v86
    v_dot2c_f32_bf16 v37, s94, v86
    v_dot2c_f32_bf16 v38, s93, v87
    v_dot2c_f32_bf16 v39, s94, v87
    s_waitcnt vmcnt(8)
    v_dot2c_f32_bf16 v32, s93, v88
    v_dot2c_f32_bf16 v33, s94, v88
    v_dot2c_f32_bf16 v34, s93, v89
    v_dot2c_f32_bf16 v35, s94, v89
    v_dot2c_f32_bf16 v36, s93, v90
    v_dot2c_f32_bf16 v37, s94, v90
    v_dot2c_f32_bf16 v38, s93, v91
    v_dot2c_f32_bf16 v39, s94, v91
    s_waitcnt vmcnt(7)
    v_dot2c_f32_bf16 v32, s93, v92
    v_dot2c_f32_bf16 v33, s94, v92
    v_dot2c_f32_bf16 v34, s93, v93
    v_dot2c_f32_bf16 v35, s94, v93
    v_dot2c_f32_bf16 v36, s93, v94
    v_dot2c_f32_bf16 v37, s94, v94
    v_dot2c_f32_bf16 v38, s93, v95
    v_dot2c_f32_bf16 v39, s94, v95
    v_cvt_pk_bf16_f32 v64, v32, v33
    v_cvt_pk_bf16_f32 v65, v34, v35
    v_cvt_pk_bf16_f32 v66, v36, v37
    v_cvt_pk_bf16_f32 v67, v38, v39
    ds_write_b128 v27, v[64:67]
    s_waitcnt lgkmcnt(0)
    s_barrier
    ds_read_b128 v[64:67], v178 offset:0
    ds_read_b128 v[68:71], v178 offset:2048
    ds_read_b128 v[72:75], v178 offset:1024
    ds_read_b128 v[76:79], v178 offset:3072
    ds_read_b128 v[80:83], v178 offset:8192
    ds_read_b128 v[84:87], v178 offset:10240
    ds_read_b128 v[88:91], v178 offset:9216
    ds_read_b128 v[92:95], v178 offset:11264
    s_add_u32 m0, s70, 16384
    s_add_u32 s86, s8, 98304
    buffer_load_dwordx4 v1, s[52:55], s86 offen lds
    s_waitcnt lgkmcnt(7)
    v_mfma_f32_32x32x16_bf16 v[16:31], v[64:67], v[128:131], 0
    s_waitcnt lgkmcnt(6)
    v_mfma_f32_32x32x16_bf16 v[32:47], v[68:71], v[136:139], 0
    s_waitcnt lgkmcnt(5)
    v_mfma_f32_32x32x16_bf16 v[16:31], v[72:75], v[132:135], v[16:31]
    s_waitcnt lgkmcnt(4)
    v_mfma_f32_32x32x16_bf16 v[32:47], v[76:79], v[140:143], v[32:47]
    s_waitcnt lgkmcnt(3)
    v_mfma_f32_32x32x16_bf16 v[16:31], v[80:83], v[128:131], v[16:31]
    s_waitcnt lgkmcnt(2)
    v_mfma_f32_32x32x16_bf16 v[32:47], v[84:87], v[136:139], v[32:47]
    s_waitcnt lgkmcnt(1)
    v_mfma_f32_32x32x16_bf16 v[16:31], v[88:91], v[132:135], v[16:31]
    s_waitcnt lgkmcnt(0)
    v_mfma_f32_32x32x16_bf16 v[32:47], v[92:95], v[140:143], v[32:47]
    s_add_u32 m0, s70, 17408
    s_add_u32 s86, s8, 106496
    buffer_load_dwordx4 v1, s[52:55], s86 offen lds
    s_nop 6
    v_add_f32 v24, 0x358637bd, v24
    s_nop 0
    v_add_f32 v40, 0x358637bd, v40
    v_rcp_f32 v24, v24
    v_rcp_f32 v40, v40
    v_mul_f32 v16, v16, v24
    v_mul_f32 v17, v17, v24
    v_mul_f32 v18, v18, v24
    v_mul_f32 v19, v19, v24
    s_add_u32 m0, s70, 32768
    s_add_u32 s86, s8, 196608
    buffer_load_dwordx4 v1, s[52:55], s86 offen lds
    v_mul_f32 v20, v20, v24
    v_mul_f32 v21, v21, v24
    v_mul_f32 v22, v22, v24
    v_mul_f32 v23, v23, v24
    v_cvt_pk_bf16_f32 v16, v16, v17
    v_cvt_pk_bf16_f32 v17, v18, v19
    v_cvt_pk_bf16_f32 v18, v20, v21
    v_cvt_pk_bf16_f32 v19, v22, v23
    s_add_u32 m0, s70, 33792
    s_add_u32 s86, s8, 204800
    buffer_load_dwordx4 v1, s[52:55], s86 offen lds
    buffer_store_dwordx4 v[16:19], v13, s[40:43], s77 offen offset:0 sc1
    v_mul_f32 v32, v32, v40
    v_mul_f32 v33, v33, v40
    v_mul_f32 v34, v34, v40
    v_mul_f32 v35, v35, v40
    v_mul_f32 v36, v36, v40
    v_mul_f32 v37, v37, v40
    v_mul_f32 v38, v38, v40
    v_mul_f32 v39, v39, v40
    v_cvt_pk_bf16_f32 v32, v32, v33
    v_cvt_pk_bf16_f32 v33, v34, v35
    v_cvt_pk_bf16_f32 v34, v36, v37
    v_cvt_pk_bf16_f32 v35, v38, v39
    buffer_store_dwordx4 v[32:35], v13, s[40:43], s77 offen offset:1024 sc1
    v_mfma_f32_32x32x16_bf16 v[96:111], v[48:51], v[160:163], v[96:111]
    ds_read_b64_tr_b16 v[60:61], v8 offset:34816
    ds_read_b64_tr_b16 v[62:63], v8 offset:35840
    v_mfma_f32_32x32x16_bf16 v[112:127], v[52:55], v[160:163], v[112:127]
    ds_read_b64_tr_b16 v[48:49], v2 offset:49152
    ds_read_b64_tr_b16 v[50:51], v2 offset:50176
    v_mfma_f32_32x32x16_bf16 v[96:111], v[56:59], v[164:167], v[96:111]
    ds_read_b64_tr_b16 v[52:53], v8 offset:49152
    ds_read_b64_tr_b16 v[54:55], v8 offset:50176
    s_waitcnt lgkmcnt(4)
    v_mfma_f32_32x32x16_bf16 v[112:127], v[60:63], v[164:167], v[112:127]
    ds_read_b64_tr_b16 v[56:57], v2 offset:51200
    ds_read_b64_tr_b16 v[58:59], v2 offset:52224
    s_waitcnt lgkmcnt(4)
    v_mfma_f32_32x32x16_bf16 v[96:111], v[48:51], v[168:171], v[96:111]
    ds_read_b64_tr_b16 v[60:61], v8 offset:51200
    ds_read_b64_tr_b16 v[62:63], v8 offset:52224
    s_waitcnt lgkmcnt(4)
    v_mfma_f32_32x32x16_bf16 v[112:127], v[52:55], v[168:171], v[112:127]
    s_waitcnt lgkmcnt(2)
    v_mfma_f32_32x32x16_bf16 v[96:111], v[56:59], v[172:175], v[96:111]
    s_waitcnt lgkmcnt(0)
    v_mfma_f32_32x32x16_bf16 v[112:127], v[60:63], v[172:175], v[112:127]
    s_cmp_lg_u32 s64, 0
    s_cbranch_scc1 L_nos_25
    buffer_load_dwordx2 v[174:175], v11, s[40:43], s84 offen offset:4 sc1
L_nos_25:
    s_cmp_lg_u32 s64, 0
    s_cbranch_scc1 L_ok_26
    s_waitcnt vmcnt(0)
    v_cmp_gt_u32 vcc, 8, v174
    s_nop 0
    s_mov_b32 s92, vcc_lo
    v_cmp_gt_u32 vcc, 16, v175
    s_nop 0
    s_or_b32 s92, s92, vcc_lo
    s_and_b32 s92, s92, 15
    s_cbranch_scc0 L_ok_26
    s_mov_b32 s91, 0
L_spin_27:
    buffer_load_dwordx2 v[174:175], v11, s[40:43], s84 offen offset:4 sc1
    s_add_u32 s91, s91, 1
    s_cmp_ge_u32 s91, 0x80000
    s_cbranch_scc1 L_ok_26
    s_waitcnt vmcnt(0)

    v_cmp_gt_u32 vcc, 8, v174
    s_nop 0
    s_mov_b32 s92, vcc_lo
    v_cmp_gt_u32 vcc, 16, v175
    s_nop 0
    s_or_b32 s92, s92, vcc_lo
    s_and_b32 s92, s92, 15
    s_cbranch_scc1 L_spin_27
L_ok_26:
    s_barrier
    ds_read_b64_tr_b16 v[48:49], v3 offset:0
    ds_read_b64_tr_b16 v[50:51], v3 offset:1024
    ds_read_b64_tr_b16 v[52:53], v9 offset:0
    ds_read_b64_tr_b16 v[54:55], v9 offset:1024
    ds_read_b64_tr_b16 v[56:57], v3 offset:2048
    ds_read_b64_tr_b16 v[58:59], v3 offset:3072
    v_lshlrev_b32 v171, 24, v0
    v_mov_b32 v170, 1
    s_waitcnt vmcnt(0)
    buffer_atomic_add v170, v171, s[40:43], s83 offen offset:12 sc1
    s_add_u32 s86, s12, 65536
    buffer_load_dwordx4 v[176:179], v13, s[40:43], s86 offen offset:0 sc1
    s_add_u32 s86, s12, 65536
    buffer_load_dwordx4 v[180:183], v13, s[40:43], s86 offen offset:1024 sc1
    s_add_u32 s86, s12, 65536
    buffer_load_dwordx4 v[184:187], v13, s[40:43], s86 offen offset:2048 sc1
    s_add_u32 s86, s12, 65536
    buffer_load_dwordx4 v[188:191], v13, s[40:43], s86 offen offset:3072 sc1
    s_add_u32 s86, s12, 69632
    buffer_load_dwordx4 v[192:195], v13, s[40:43], s86 offen offset:0 sc1
    s_add_u32 s86, s12, 69632
    buffer_load_dwordx4 v[196:199], v13, s[40:43], s86 offen offset:1024 sc1
    s_add_u32 s86, s12, 69632
    buffer_load_dwordx4 v[200:203], v13, s[40:43], s86 offen offset:2048 sc1
    s_add_u32 s86, s12, 69632
    buffer_load_dwordx4 v[204:207], v13, s[40:43], s86 offen offset:3072 sc1
    s_waitcnt vmcnt(7) lgkmcnt(4)
    v_mfma_f32_32x32x16_bf16 v[96:111], v[48:51], v[176:179], v[96:111]
    ds_read_b64_tr_b16 v[60:61], v9 offset:2048
    ds_read_b64_tr_b16 v[62:63], v9 offset:3072
    s_add_u32 m0, s70, 49152
    s_add_u32 s86, s8, 229376
    buffer_load_dwordx4 v1, s[52:55], s86 offen lds
    s_waitcnt lgkmcnt(4)
    v_mfma_f32_32x32x16_bf16 v[112:127], v[52:55], v[176:179], v[112:127]
    ds_read_b64_tr_b16 v[48:49], v3 offset:16384
    ds_read_b64_tr_b16 v[50:51], v3 offset:17408
    s_add_u32 m0, s70, 50176
    s_add_u32 s86, s8, 237568
    buffer_load_dwordx4 v1, s[52:55], s86 offen lds
    s_waitcnt vmcnt(8) lgkmcnt(4)
    v_mfma_f32_32x32x16_bf16 v[96:111], v[56:59], v[180:183], v[96:111]
    ds_read_b64_tr_b16 v[52:53], v9 offset:16384
    ds_read_b64_tr_b16 v[54:55], v9 offset:17408
    s_add_u32 s86, s11, 4096
    buffer_load_dwordx4 v[208:211], v13, s[40:43], s86 offen offset:0 sc1
    s_waitcnt lgkmcnt(4)
    v_mfma_f32_32x32x16_bf16 v[112:127], v[60:63], v[180:183], v[112:127]
    ds_read_b64_tr_b16 v[56:57], v3 offset:18432
    ds_read_b64_tr_b16 v[58:59], v3 offset:19456
    s_add_u32 s86, s11, 4096
    buffer_load_dwordx4 v[212:215], v13, s[40:43], s86 offen offset:1024 sc1
    s_waitcnt vmcnt(9) lgkmcnt(4)
    v_mfma_f32_32x32x16_bf16 v[96:111], v[48:51], v[184:187], v[96:111]
    ds_read_b64_tr_b16 v[60:61], v9 offset:18432
    ds_read_b64_tr_b16 v[62:63], v9 offset:19456
    s_add_u32 s86, s11, 4096
    buffer_load_dwordx4 v[216:219], v13, s[40:43], s86 offen offset:2048 sc1
    s_waitcnt lgkmcnt(4)
    s_barrier
    v_mfma_f32_32x32x16_bf16 v[112:127], v[52:55], v[184:187], v[112:127]
    ds_read_b64_tr_b16 v[48:49], v3 offset:32768
    ds_read_b64_tr_b16 v[50:51], v3 offset:33792
    s_add_u32 s86, s11, 4096
    buffer_load_dwordx4 v[220:223], v13, s[40:43], s86 offen offset:3072 sc1
    s_waitcnt vmcnt(10) lgkmcnt(4)
    v_mfma_f32_32x32x16_bf16 v[96:111], v[56:59], v[188:191], v[96:111]
    ds_read_b64_tr_b16 v[52:53], v9 offset:32768
    ds_read_b64_tr_b16 v[54:55], v9 offset:33792
    s_add_u32 m0, s70, 65536
    s_add_u32 s86, s10, 1572864
    buffer_load_dwordx4 v1, s[52:55], s86 offen lds
    s_waitcnt lgkmcnt(4)
    v_mfma_f32_32x32x16_bf16 v[112:127], v[60:63], v[188:191], v[112:127]
    ds_read_b64_tr_b16 v[56:57], v3 offset:34816
    ds_read_b64_tr_b16 v[58:59], v3 offset:35840
    s_add_u32 m0, s70, 66560
    s_add_u32 s86, s10, 1581056
    buffer_load_dwordx4 v1, s[52:55], s86 offen lds
    s_waitcnt vmcnt(11) lgkmcnt(4)
    v_mfma_f32_32x32x16_bf16 v[96:111], v[48:51], v[192:195], v[96:111]
    ds_read_b64_tr_b16 v[60:61], v9 offset:34816
    ds_read_b64_tr_b16 v[62:63], v9 offset:35840
    s_add_u32 s86, s11, 12288
    buffer_load_dwordx4 v[224:227], v13, s[40:43], s86 offen offset:0 sc1
    s_waitcnt lgkmcnt(4)
    v_mfma_f32_32x32x16_bf16 v[112:127], v[52:55], v[192:195], v[112:127]
    ds_read_b64_tr_b16 v[48:49], v3 offset:49152
    ds_read_b64_tr_b16 v[50:51], v3 offset:50176
    s_add_u32 s86, s11, 12288
    buffer_load_dwordx4 v[228:231], v13, s[40:43], s86 offen offset:1024 sc1
    s_waitcnt vmcnt(12) lgkmcnt(4)
    v_mfma_f32_32x32x16_bf16 v[96:111], v[56:59], v[196:199], v[96:111]
    ds_read_b64_tr_b16 v[52:53], v9 offset:49152
    ds_read_b64_tr_b16 v[54:55], v9 offset:50176
    s_add_u32 s86, s11, 12288
    buffer_load_dwordx4 v[232:235], v13, s[40:43], s86 offen offset:2048 sc1
    s_waitcnt lgkmcnt(4)
    v_mfma_f32_32x32x16_bf16 v[112:127], v[60:63], v[196:199], v[112:127]
    ds_read_b64_tr_b16 v[56:57], v3 offset:51200
    ds_read_b64_tr_b16 v[58:59], v3 offset:52224
    s_add_u32 s86, s11, 12288
    buffer_load_dwordx4 v[236:239], v13, s[40:43], s86 offen offset:3072 sc1
    s_waitcnt vmcnt(13) lgkmcnt(4)
    v_mfma_f32_32x32x16_bf16 v[96:111], v[48:51], v[200:203], v[96:111]
    ds_read_b64_tr_b16 v[60:61], v9 offset:51200
    ds_read_b64_tr_b16 v[62:63], v9 offset:52224
    s_add_u32 s86, s13, 98304
    buffer_load_dwordx4 v[240:243], v13, s[40:43], s86 offen offset:0 sc1
    s_waitcnt lgkmcnt(4)
    s_barrier
    v_mfma_f32_32x32x16_bf16 v[112:127], v[52:55], v[200:203], v[112:127]
    ds_read_b64_tr_b16 v[48:49], v10 offset:0
    ds_read_b64_tr_b16 v[50:51], v10 offset:1024
    s_add_u32 m0, s70, 81920
    s_add_u32 s86, s10, 1605632
    buffer_load_dwordx4 v1, s[52:55], s86 offen lds
    s_waitcnt vmcnt(14) lgkmcnt(4)
    v_mfma_f32_32x32x16_bf16 v[96:111], v[56:59], v[204:207], v[96:111]
    ds_read_b64_tr_b16 v[52:53], v12 offset:0
    ds_read_b64_tr_b16 v[54:55], v12 offset:1024
    s_add_u32 m0, s70, 82944
    s_add_u32 s86, s10, 1613824
    buffer_load_dwordx4 v1, s[52:55], s86 offen lds
    s_waitcnt lgkmcnt(4)
    v_mfma_f32_32x32x16_bf16 v[112:127], v[60:63], v[204:207], v[112:127]
    ds_read_b64_tr_b16 v[56:57], v10 offset:2048
    ds_read_b64_tr_b16 v[58:59], v10 offset:3072
    s_add_u32 m0, s70, 98304
    s_add_u32 s86, s9, 0
    buffer_load_dwordx4 v1, s[56:59], s86 offen lds
    s_waitcnt vmcnt(13) lgkmcnt(4)
    v_mfma_f32_32x32x16_bf16 v[96:111], v[48:51], v[208:211], v[96:111]
    ds_read_b64_tr_b16 v[60:61], v12 offset:2048
    ds_read_b64_tr_b16 v[62:63], v12 offset:3072
    s_add_u32 m0, s70, 99328
    s_add_u32 s86, s9, 8192
    buffer_load_dwordx4 v1, s[56:59], s86 offen lds
    s_waitcnt lgkmcnt(4)
    v_mfma_f32_32x32x16_bf16 v[112:127], v[52:55], v[208:211], v[112:127]
    ds_read_b64_tr_b16 v[48:49], v2 offset:0
    ds_read_b64_tr_b16 v[50:51], v2 offset:1024
    s_add_u32 s86, s13, 98304
    buffer_load_dwordx4 v[244:247], v13, s[40:43], s86 offen offset:1024 sc1
    s_waitcnt vmcnt(14) lgkmcnt(4)
    v_mfma_f32_32x32x16_bf16 v[96:111], v[56:59], v[212:215], v[96:111]
    ds_read_b64_tr_b16 v[52:53], v8 offset:0
    ds_read_b64_tr_b16 v[54:55], v8 offset:1024
    s_add_u32 s86, s13, 98304
    buffer_load_dwordx4 v[248:251], v13, s[40:43], s86 offen offset:2048 sc1
    s_waitcnt lgkmcnt(4)
    v_mfma_f32_32x32x16_bf16 v[112:127], v[60:63], v[212:215], v[112:127]
    ds_read_b64_tr_b16 v[56:57], v2 offset:2048
    ds_read_b64_tr_b16 v[58:59], v2 offset:3072
    s_add_u32 s86, s13, 98304
    buffer_load_dwordx4 v[252:255], v13, s[40:43], s86 offen offset:3072 sc1
    s_cmp_lg_u32 s64, 0
    s_cbranch_scc1 L_nos_28
    buffer_load_dword v174, v11, s[40:43], s84 offen offset:12 sc1
L_nos_28:
    s_waitcnt vmcnt(15) lgkmcnt(4)
    v_mfma_f32_32x32x16_bf16 v[96:111], v[48:51], v[216:219], v[96:111]
    ds_read_b64_tr_b16 v[60:61], v8 offset:2048
    ds_read_b64_tr_b16 v[62:63], v8 offset:3072
    s_waitcnt lgkmcnt(4)
    s_barrier
    v_mfma_f32_32x32x16_bf16 v[112:127], v[52:55], v[216:219], v[112:127]
    ds_read_b64_tr_b16 v[48:49], v2 offset:16384
    ds_read_b64_tr_b16 v[50:51], v2 offset:17408
    s_add_u32 m0, s70, 114688
    s_add_u32 s86, s9, 32768
    buffer_load_dwordx4 v1, s[56:59], s86 offen lds
    s_waitcnt vmcnt(15) lgkmcnt(4)
    v_mfma_f32_32x32x16_bf16 v[96:111], v[56:59], v[220:223], v[96:111]
    ds_read_b64_tr_b16 v[52:53], v8 offset:16384
    ds_read_b64_tr_b16 v[54:55], v8 offset:17408
    s_add_u32 m0, s70, 115712
    s_add_u32 s86, s9, 40960
    buffer_load_dwordx4 v1, s[56:59], s86 offen lds
    s_waitcnt lgkmcnt(4)
    v_mfma_f32_32x32x16_bf16 v[112:127], v[60:63], v[220:223], v[112:127]
    ds_read_b64_tr_b16 v[56:57], v2 offset:18432
    ds_read_b64_tr_b16 v[58:59], v2 offset:19456
    s_add_u32 m0, s70, 131072
    s_add_u32 s86, s9, 65536
    buffer_load_dwordx4 v1, s[56:59], s86 offen lds
    s_cmp_lg_u32 s64, 0
    s_cbranch_scc1 L_ok_29
    s_waitcnt vmcnt(3)
    v_cmp_gt_u32 vcc, 8, v174
    s_nop 0
    s_mov_b32 s92, vcc_lo
    s_and_b32 s92, s92, 15
    s_cbranch_scc0 L_ok_29
    s_mov_b32 s91, 0
L_spin_30:
    buffer_load_dword v174, v11, s[40:43], s84 offen offset:12 sc1
    s_add_u32 s91, s91, 1
    s_cmp_ge_u32 s91, 0x80000
    s_cbranch_scc1 L_ok_29
    s_waitcnt vmcnt(0)

    v_cmp_gt_u32 vcc, 8, v174
    s_nop 0
    s_mov_b32 s92, vcc_lo
    s_and_b32 s92, s92, 15
    s_cbranch_scc1 L_spin_30
L_ok_29:
    s_barrier
    s_waitcnt vmcnt(14) lgkmcnt(4)
    v_mfma_f32_32x32x16_bf16 v[96:111], v[48:51], v[224:227], v[96:111]
    ds_read_b64_tr_b16 v[60:61], v8 offset:18432
    ds_read_b64_tr_b16 v[62:63], v8 offset:19456
    s_add_u32 s86, s12, 114688
    buffer_load_dwordx4 v[144:147], v13, s[40:43], s86 offen offset:0 sc1
    s_waitcnt lgkmcnt(4)
    v_mfma_f32_32x32x16_bf16 v[112:127], v[52:55], v[224:227], v[112:127]
    ds_read_b64_tr_b16 v[48:49], v2 offset:32768
    ds_read_b64_tr_b16 v[50:51], v2 offset:33792
    s_add_u32 s86, s12, 114688
    buffer_load_dwordx4 v[148:151], v13, s[40:43], s86 offen offset:1024 sc1
    s_waitcnt vmcnt(15) lgkmcnt(4)
    v_mfma_f32_32x32x16_bf16 v[96:111], v[56:59], v[228:231], v[96:111]
    ds_read_b64_tr_b16 v[52:53], v8 offset:32768
    ds_read_b64_tr_b16 v[54:55], v8 offset:33792
    s_add_u32 s86, s12, 114688
    buffer_load_dwordx4 v[152:155], v13, s[40:43], s86 offen offset:2048 sc1
    s_waitcnt lgkmcnt(4)
    v_mfma_f32_32x32x16_bf16 v[112:127], v[60:63], v[228:231], v[112:127]
    ds_read_b64_tr_b16 v[56:57], v2 offset:34816
    ds_read_b64_tr_b16 v[58:59], v2 offset:35840
    s_add_u32 s86, s12, 114688
    buffer_load_dwordx4 v[156:159], v13, s[40:43], s86 offen offset:3072 sc1
    s_waitcnt vmcnt(16) lgkmcnt(4)
    v_mfma_f32_32x32x16_bf16 v[96:111], v[48:51], v[232:235], v[96:111]
    ds_read_b64_tr_b16 v[60:61], v8 offset:34816
    ds_read_b64_tr_b16 v[62:63], v8 offset:35840
    s_add_u32 m0, s70, 132096
    s_add_u32 s86, s9, 73728
    buffer_load_dwordx4 v1, s[56:59], s86 offen lds
    s_waitcnt lgkmcnt(4)
    s_waitcnt vmcnt(13)
    s_barrier
    v_mfma_f32_32x32x16_bf16 v[112:127], v[52:55], v[232:235], v[112:127]
    ds_read_b64_tr_b16 v[48:49], v2 offset:49152
    ds_read_b64_tr_b16 v[50:51], v2 offset:50176
    s_add_u32 m0, s70, 147456
    s_add_u32 s86, s9, 98304
    buffer_load_dwordx4 v1, s[56:59], s86 offen lds
    s_waitcnt lgkmcnt(4)
    v_mfma_f32_32x32x16_bf16 v[96:111], v[56:59], v[236:239], v[96:111]
    ds_read_b64_tr_b16 v[52:53], v8 offset:49152
    ds_read_b64_tr_b16 v[54:55], v8 offset:50176
    s_add_u32 m0, s70, 148480
    s_add_u32 s86, s9, 106496
    buffer_load_dwordx4 v1, s[56:59], s86 offen lds
    s_waitcnt lgkmcnt(4)
    v_mfma_f32_32x32x16_bf16 v[112:127], v[60:63], v[236:239], v[112:127]
    ds_read_b64_tr_b16 v[56:57], v2 offset:51200
    ds_read_b64_tr_b16 v[58:59], v2 offset:52224
    s_add_u32 s86, s12, 118784
    buffer_load_dwordx4 v[160:163], v13, s[40:43], s86 offen offset:0 sc1
    s_waitcnt lgkmcnt(4)
    v_mfma_f32_32x32x16_bf16 v[96:111], v[48:51], v[240:243], v[96:111]
    ds_read_b64_tr_b16 v[60:61], v8 offset:51200
    ds_read_b64_tr_b16 v[62:63], v8 offset:52224
    s_add_u32 s86, s12, 118784
    buffer_load_dwordx4 v[164:167], v13, s[40:43], s86 offen offset:1024 sc1
    s_waitcnt lgkmcnt(4)
    v_mfma_f32_32x32x16_bf16 v[112:127], v[52:55], v[240:243], v[112:127]
    ds_read_b64_tr_b16 v[48:49], v3 offset:0
    ds_read_b64_tr_b16 v[50:51], v3 offset:1024
    s_add_u32 s86, s12, 118784
    buffer_load_dwordx4 v[168:171], v13, s[40:43], s86 offen offset:2048 sc1
    s_waitcnt vmcnt(15) lgkmcnt(4)
    v_mfma_f32_32x32x16_bf16 v[96:111], v[56:59], v[244:247], v[96:111]
    ds_read_b64_tr_b16 v[52:53], v9 offset:0
    ds_read_b64_tr_b16 v[54:55], v9 offset:1024
    s_add_u32 s86, s12, 118784
    buffer_load_dwordx4 v[172:175], v13, s[40:43], s86 offen offset:3072 sc1
    s_waitcnt lgkmcnt(4)
    v_mfma_f32_32x32x16_bf16 v[112:127], v[60:63], v[244:247], v[112:127]
    ds_read_b64_tr_b16 v[56:57], v3 offset:2048
    ds_read_b64_tr_b16 v[58:59], v3 offset:3072
    s_waitcnt vmcnt(15) lgkmcnt(4)
    v_mfma_f32_32x32x16_bf16 v[96:111], v[48:51], v[248:251], v[96:111]
    ds_read_b64_tr_b16 v[60:61], v9 offset:2048
    ds_read_b64_tr_b16 v[62:63], v9 offset:3072
    s_waitcnt lgkmcnt(4)
    s_waitcnt vmcnt(12)
    s_barrier
    v_mfma_f32_32x32x16_bf16 v[112:127], v[52:55], v[248:251], v[112:127]
    ds_read_b64_tr_b16 v[48:49], v3 offset:16384
    ds_read_b64_tr_b16 v[50:51], v3 offset:17408
    s_lshl_b32 s87, s26, 3
    s_add_u32 s87, s87, s64
    s_lshl_b32 s87, s87, 13
    s_lshl_b32 s88, s27, 7
    s_add_u32 s87, s87, s88
    v_lshrrev_b32 v39, 3, v0
    v_and_b32 v35, 7, v0
    v_lshlrev_b32 v36, 10, v39
    v_lshl_add_u32 v36, v35, 4, v36
    v_add_u32 v36, s87, v36
    s_lshl_b32 s87, s64, 3
    v_add_u32 v39, s87, v39
    v_mul_u32_u24 v38, 272, v39
    v_lshl_add_u32 v38, v35, 5, v38
    v_and_b32 v39, 31, v0
    s_lshl_b32 s87, s17, 5
    v_add_u32 v39, s87, v39
    v_mul_u32_u24 v37, 272, v39
    v_lshrrev_b32 v39, 5, v0
    v_lshl_add_u32 v37, v39, 4, v37
    s_mul_i32 s87, s16, 17408
    v_add_u32 v37, s87, v37
    buffer_load_dwordx4 v[40:43], v36, s[28:31], 0 offen
    s_waitcnt lgkmcnt(4)
    v_mfma_f32_32x32x16_bf16 v[96:111], v[56:59], v[252:255], v[96:111]
    ds_read_b64_tr_b16 v[52:53], v9 offset:16384
    ds_read_b64_tr_b16 v[54:55], v9 offset:17408
    s_waitcnt lgkmcnt(4)
    v_mfma_f32_32x32x16_bf16 v[112:127], v[60:63], v[252:255], v[112:127]
    ds_read_b64_tr_b16 v[56:57], v3 offset:18432
    ds_read_b64_tr_b16 v[58:59], v3 offset:19456
    s_waitcnt vmcnt(11) lgkmcnt(4)
    v_mfma_f32_32x32x16_bf16 v[96:111], v[48:51], v[144:147], v[96:111]
    ds_read_b64_tr_b16 v[60:61], v9 offset:18432
    ds_read_b64_tr_b16 v[62:63], v9 offset:19456
    s_waitcnt lgkmcnt(4)
    v_mfma_f32_32x32x16_bf16 v[112:127], v[52:55], v[144:147], v[112:127]
    ds_read_b64_tr_b16 v[48:49], v3 offset:32768
    ds_read_b64_tr_b16 v[50:51], v3 offset:33792
    s_waitcnt vmcnt(10) lgkmcnt(4)
    v_mfma_f32_32x32x16_bf16 v[96:111], v[56:59], v[148:151], v[96:111]
    ds_read_b64_tr_b16 v[52:53], v9 offset:32768
    ds_read_b64_tr_b16 v[54:55], v9 offset:33792
    s_waitcnt lgkmcnt(4)
    v_mfma_f32_32x32x16_bf16 v[112:127], v[60:63], v[148:151], v[112:127]
    ds_read_b64_tr_b16 v[56:57], v3 offset:34816
    ds_read_b64_tr_b16 v[58:59], v3 offset:35840
    s_waitcnt vmcnt(9) lgkmcnt(4)
    v_mfma_f32_32x32x16_bf16 v[96:111], v[48:51], v[152:155], v[96:111]
    ds_read_b64_tr_b16 v[60:61], v9 offset:34816
    ds_read_b64_tr_b16 v[62:63], v9 offset:35840
    s_waitcnt lgkmcnt(4)
    s_waitcnt vmcnt(5)
    s_barrier
    v_mfma_f32_32x32x16_bf16 v[112:127], v[52:55], v[152:155], v[112:127]
    ds_read_b64_tr_b16 v[48:49], v3 offset:49152
    ds_read_b64_tr_b16 v[50:51], v3 offset:50176
    s_waitcnt lgkmcnt(4)
    v_mfma_f32_32x32x16_bf16 v[96:111], v[56:59], v[156:159], v[96:111]
    ds_read_b64_tr_b16 v[52:53], v3 offset:51200
    ds_read_b64_tr_b16 v[54:55], v3 offset:52224
    s_waitcnt lgkmcnt(4)
    v_mfma_f32_32x32x16_bf16 v[112:127], v[60:63], v[156:159], v[112:127]
    ds_read_b64_tr_b16 v[56:57], v10 offset:0
    ds_read_b64_tr_b16 v[58:59], v10 offset:1024
    s_waitcnt vmcnt(4) lgkmcnt(4)
    v_mfma_f32_32x32x16_bf16 v[96:111], v[48:51], v[160:163], v[96:111]
    ds_read_b64_tr_b16 v[60:61], v10 offset:2048
    ds_read_b64_tr_b16 v[62:63], v10 offset:3072
    s_waitcnt vmcnt(3) lgkmcnt(4)
    v_mfma_f32_32x32x16_bf16 v[96:111], v[52:55], v[164:167], v[96:111]
    ds_read_b64_tr_b16 v[48:49], v9 offset:49152
    ds_read_b64_tr_b16 v[50:51], v9 offset:50176
    s_waitcnt vmcnt(2) lgkmcnt(4)
    v_mfma_f32_32x32x16_bf16 v[96:111], v[56:59], v[168:171], v[96:111]
    ds_read_b64_tr_b16 v[52:53], v9 offset:51200
    ds_read_b64_tr_b16 v[54:55], v9 offset:52224
    s_waitcnt vmcnt(1) lgkmcnt(4)
    v_mfma_f32_32x32x16_bf16 v[96:111], v[60:63], v[172:175], v[96:111]
    ds_read_b64_tr_b16 v[56:57], v12 offset:0
    ds_read_b64_tr_b16 v[58:59], v12 offset:1024
    s_waitcnt lgkmcnt(4)
    v_mfma_f32_32x32x16_bf16 v[112:127], v[48:51], v[160:163], v[112:127]
    ds_read_b64_tr_b16 v[60:61], v12 offset:2048
    ds_read_b64_tr_b16 v[62:63], v12 offset:3072
    s_waitcnt lgkmcnt(4)
    v_mfma_f32_32x32x16_bf16 v[112:127], v[52:55], v[164:167], v[112:127]
    s_waitcnt lgkmcnt(2)
    v_mfma_f32_32x32x16_bf16 v[112:127], v[56:59], v[168:171], v[112:127]
    s_nop 1
    ds_write_b128 v37, v[96:99] offset:0
    ds_write_b128 v37, v[100:103] offset:32
    s_waitcnt lgkmcnt(2)
    v_mfma_f32_32x32x16_bf16 v[112:127], v[60:63], v[172:175], v[112:127]
    ds_write_b128 v37, v[104:107] offset:64
    ds_write_b128 v37, v[108:111] offset:96
    s_nop 9
    ds_write_b128 v37, v[112:115] offset:128
    ds_write_b128 v37, v[116:119] offset:160
    ds_write_b128 v37, v[120:123] offset:192
    ds_write_b128 v37, v[124:127] offset:224
    s_waitcnt vmcnt(0)
    v_lshlrev_b32 v16, 16, v40
    v_and_b32 v17, s81, v40
    v_lshlrev_b32 v18, 16, v41
    v_and_b32 v19, s81, v41
    v_lshlrev_b32 v20, 16, v42
    v_and_b32 v21, s81, v42
    v_lshlrev_b32 v22, 16, v43
    v_and_b32 v23, s81, v43
    s_waitcnt lgkmcnt(0)
    s_barrier
    ds_read_b128 v[128:131], v38 offset:0
    ds_read_b128 v[132:135], v38 offset:16
    ds_read_b128 v[136:139], v38 offset:17408
    ds_read_b128 v[140:143], v38 offset:17424
    ds_read_b128 v[144:147], v38 offset:34816
    ds_read_b128 v[148:151], v38 offset:34832
    ds_read_b128 v[152:155], v38 offset:52224
    ds_read_b128 v[156:159], v38 offset:52240
    s_waitcnt lgkmcnt(7)
    v_add_f32 v16, v16, v128
    v_add_f32 v17, v17, v129
    v_add_f32 v18, v18, v130
    v_add_f32 v19, v19, v131
    s_waitcnt lgkmcnt(6)
    v_add_f32 v20, v20, v132
    v_add_f32 v21, v21, v133
    v_add_f32 v22, v22, v134
    v_add_f32 v23, v23, v135
    s_waitcnt lgkmcnt(5)
    v_add_f32 v16, v16, v136
    v_add_f32 v17, v17, v137
    v_add_f32 v18, v18, v138
    v_add_f32 v19, v19, v139
    s_waitcnt lgkmcnt(4)
    v_add_f32 v20, v20, v140
    v_add_f32 v21, v21, v141
    v_add_f32 v22, v22, v142
    v_add_f32 v23, v23, v143
    s_waitcnt lgkmcnt(3)
    v_add_f32 v16, v16, v144
    v_add_f32 v17, v17, v145
    v_add_f32 v18, v18, v146
    v_add_f32 v19, v19, v147
    s_waitcnt lgkmcnt(2)
    v_add_f32 v20, v20, v148
    v_add_f32 v21, v21, v149
    v_add_f32 v22, v22, v150
    v_add_f32 v23, v23, v151
    s_waitcnt lgkmcnt(1)
    v_add_f32 v16, v16, v152
    v_add_f32 v17, v17, v153
    v_add_f32 v18, v18, v154
    v_add_f32 v19, v19, v155
    s_waitcnt lgkmcnt(0)
    v_add_f32 v20, v20, v156
    v_add_f32 v21, v21, v157
    v_add_f32 v22, v22, v158
    v_add_f32 v23, v23, v159
    v_cvt_pk_bf16_f32 v24, v16, v17
    v_cvt_pk_bf16_f32 v25, v18, v19
    v_cvt_pk_bf16_f32 v26, v20, v21
    v_cvt_pk_bf16_f32 v27, v22, v23
    buffer_store_dwordx4 v[24:27], v36, s[60:63], 0 offen
L_end:
L_last:
    s_endpgm
.section .rodata,"a"
.p2align 6
.amdhsa_kernel parallel_sum__linear_kernel_hedgehog__swiglu_ffn__prompt_kernel
  .amdhsa_next_free_vgpr 256
  .amdhsa_next_free_sgpr 102
  .amdhsa_accum_offset 256
  .amdhsa_group_segment_fixed_size 0
  .amdhsa_kernarg_size 88
  .amdhsa_user_sgpr_count 2
  .amdhsa_user_sgpr_kernarg_segment_ptr 1
  .amdhsa_system_sgpr_workgroup_id_x 1
  .amdhsa_float_denorm_mode_32 3
  .amdhsa_float_denorm_mode_16_64 3
.end_amdhsa_kernel
```
